```python
import torch

def _softmax(x, axis=-1):
    return torch.softmax(x, dim=axis)
def _gelu(x):
    return torch.nn.functional.gelu(x, approximate="tanh")
def _silu(x):
    return torch.nn.functional.silu(x)
def _sigmoid(x):
    return torch.sigmoid(x)
def _layernorm(x, axis=-1, eps=1e-5):
    m = x.mean(dim=axis, keepdim=True)
    v = x.var(dim=axis, keepdim=True, unbiased=False)
    return (x - m) / torch.sqrt(v + eps)
def _scatter_add(tgt, idx, src, axis=0):
    return tgt.clone().index_add_(axis, idx, src)
def _segment_sum(src, seg, n):
    out = torch.zeros((n,) + src.shape[1:], dtype=src.dtype)
    return out.index_add_(0, seg, src)
def _pad(x, pw):
    flat = tuple(v for pair in reversed(pw) for v in pair)
    return torch.nn.functional.pad(x, flat)

kernel_name = 'sequential_preLN__spectral_fnet__geglu_ffn__prompt'

def setup_inputs():

    _w = (lambda a: (lambda t: t.to(torch.bfloat16) if t.is_floating_point() else t)(torch.as_tensor(a)))
    def _A_setup():
        B, S, D = 1, 2048, 512
        ns = torch.arange(S)[:, None] * torch.arange(S)[None, :]
        nd = torch.arange(D)[:, None] * torch.arange(D)[None, :]
        Ws_re = torch.cos(-2.0 * torch.pi * ns / S).to(float)
        Ws_im = torch.sin(-2.0 * torch.pi * ns / S).to(float)
        Wd_re = torch.cos(-2.0 * torch.pi * nd / D).to(float)
        Wd_im = torch.sin(-2.0 * torch.pi * nd / D).to(float)
        return {
            "x": _w((lambda *s: torch.randn(*s, dtype=torch.bfloat16) * 0.05)(B, S, D)),
            "dft_seq_re": _w(Ws_re),
            "dft_seq_im": _w(Ws_im),
            "dft_hid_re": _w(Wd_re),
            "dft_hid_im": _w(Wd_im),
        }
    _A_in = _A_setup()

    def _B_setup():
        B, S, D, F = 1, 2048, 512, 1792
        return {
            "x": _w((lambda *s: torch.randn(*s, dtype=torch.bfloat16) * 0.05)(B, S, D)),
            "w_gate": _w((lambda *s: torch.randn(*s, dtype=torch.bfloat16) * 0.2)(D, F)),
            "w_up": _w((lambda *s: torch.randn(*s, dtype=torch.bfloat16) * 0.2)(D, F)),
            "w_down": _w((lambda *s: torch.randn(*s, dtype=torch.bfloat16) * 0.2)(F, D)),
        }
    _B_in = _B_setup()

    return {
        "A_x": _A_in["x"],
        "A_dft_seq_re": _A_in["dft_seq_re"],
        "A_dft_seq_im": _A_in["dft_seq_im"],
        "A_dft_hid_re": _A_in["dft_hid_re"],
        "A_dft_hid_im": _A_in["dft_hid_im"],
        "B_x": _B_in["x"],
        "B_w_gate": _B_in["w_gate"],
        "B_w_up": _B_in["w_up"],
        "B_w_down": _B_in["w_down"],
    }

def reference(A_x, A_dft_seq_re, A_dft_seq_im, A_dft_hid_re, A_dft_hid_im, B_x, B_w_gate, B_w_up, B_w_down):
    def _A_ref(x, dft_seq_re, dft_seq_im, dft_hid_re, dft_hid_im):
        a = torch.einsum("bsd,ed->bse", x, dft_hid_re)
        b = torch.einsum("bsd,ed->bse", x, dft_hid_im)
        y = torch.einsum("ts,bse->bte", dft_seq_re, a) - torch.einsum("ts,bse->bte", dft_seq_im, b)
        return y

    def _B_ref(x, w_gate, w_up, w_down):
        return (_gelu(x @ w_gate) * (x @ w_up)) @ w_down

    x = A_x
    h = x + _A_ref(_layernorm(x, axis=-1), A_dft_seq_re, A_dft_seq_im, A_dft_hid_re, A_dft_hid_im)
    h2 = h + _B_ref(_layernorm(h, axis=-1), B_w_gate, B_w_up, B_w_down)
    return h2
```

```asm
; @launch grid=(256,1,1) block=(256,1,1) lds=163840
.amdgcn_target "amdgcn-amd-amdhsa--gfx950"
.text
.globl sequential_preLN__spectral_fnet__geglu_ffn__prompt_kernel
.p2align 8
.type sequential_preLN__spectral_fnet__geglu_ffn__prompt_kernel,@function
sequential_preLN__spectral_fnet__geglu_ffn__prompt_kernel:
  s_cmp_ge_u32 s2, 256
  s_cbranch_scc1 L_END
  s_load_dwordx2 s[4:5], s[0:1], 0
  s_load_dwordx4 s[40:43], s[0:1], 48
  s_load_dwordx4 s[44:47], s[0:1], 64
  s_load_dwordx4 s[48:51], s[0:1], 80
  v_lshrrev_b32 v6, 6, v0
  v_and_b32 v1, 63, v0
  v_readfirstlane_b32 s36, v6
  s_getpc_b64 s[32:33]
L_PC:
  v_lshlrev_b32 v144, 4, v1
  s_add_u32 s32, s32, L_TBL-L_PC
  s_addc_u32 s33, s33, 0
  s_mov_b32 s34, 8192
  s_mov_b32 s35, 0x20000
  s_lshl_b32 s63, s36, 11
  s_add_u32 m0, s63, 139264
  s_nop 0
  buffer_load_dwordx4 v144, s[32:35], s63 offen lds
  buffer_load_dwordx4 v144, s[32:35], s63 offen offset:1024 lds
  s_and_b32 s37, s2, 7
  s_lshr_b32 s38, s2, 3
  s_lshr_b32 s59, s38, 4
  s_and_b32 s60, s38, 15
  s_lshl_b32 s61, s37, 1
  s_add_u32 s61, s61, s59
  s_lshr_b32 s57, s37, 1
  s_and_b32 s58, s37, 1
  s_lshl_b32 s62, s58, 2
  s_lshl_b32 s58, s58, 7
  s_cmp_lt_u32 s37, 2
  s_cselect_b32 s56, 1, 0
  s_cselect_b32 s57, s62, s57
  s_cselect_b32 s58, 0, s58
  v_and_b32 v2, 15, v1
  v_lshrrev_b32 v3, 4, v1
  v_and_b32 v4, 31, v1
  v_lshrrev_b32 v5, 5, v1
  s_mov_b32 s6, 0x200000
  s_mov_b32 s7, 0x20000
  s_lshl_b32 s62, s36, 9
  s_add_u32 s62, s62, s2
  s_lshl_b32 s62, s62, 10
  s_add_u32 m0, s63, 131072
  s_waitcnt lgkmcnt(0)
  buffer_load_dwordx4 v144, s[4:7], s62 offen lds
  s_add_u32 s62, s62, 261120
  buffer_load_dwordx4 v144, s[4:7], s62 offen offset:1024 lds
  s_mov_b32 s8, s40
  s_mov_b32 s9, s41
  s_mov_b32 s10, 1835008
  s_mov_b32 s11, 0x20000
  s_mov_b32 s12, s42
  s_mov_b32 s13, s43
  s_mov_b32 s14, 1835008
  s_mov_b32 s15, 0x20000
  s_mov_b32 s16, s44
  s_mov_b32 s17, s45
  s_mov_b32 s18, 1835008
  s_mov_b32 s19, 0x20000
  s_mov_b32 s20, s46
  s_mov_b32 s21, s47
  s_mov_b32 s22, 2097152
  s_mov_b32 s23, 0x20000
  s_mov_b32 s28, s48
  s_mov_b32 s29, s49
  s_mov_b32 s30, 256
  s_mov_b32 s31, 0x20000
  s_mov_b32 s24, s50
  s_mov_b32 s25, s51
  s_mov_b32 s26, 15728640
  s_mov_b32 s27, 0x20000
  s_or_b32 s62, s2, s36
  s_cmp_lg_u32 s62, 0
  s_cbranch_scc1 L_NN
  s_memrealtime s[92:93]
  s_mov_b64 exec, 1
  v_mov_b32 v8, 0
  s_waitcnt lgkmcnt(0)
  s_or_b32 s92, s92, 1
  v_mov_b32 v9, s92
  buffer_store_dword v9, v8, s[28:31], 0 offen sc1
  s_mov_b64 exec, -1
L_NN:
  v_lshrrev_b32 v8, 3, v1
  v_bfe_u32 v9, v1, 2, 1
  v_bfe_u32 v30, v1, 4, 1
  v_xor_b32 v9, v9, v30
  v_lshlrev_b32 v9, 6, v9
  v_lshl_add_u32 v9, v8, 10, v9
  v_and_b32 v8, 3, v1
  v_lshl_add_u32 v30, v8, 4, v9
  s_sub_u32 s62, s2, 32
  s_cmp_lt_u32 s2, 224
  s_cselect_b32 s62, s2, s62
  s_mul_i32 s63, s62, 2341
  s_lshr_b32 s63, s63, 16
  s_lshl_b32 s62, s62, 2
  s_add_u32 s90, s62, s36
  s_mul_i32 s62, s63, 112
  s_sub_u32 s62, s90, s62
  s_lshl_b32 s62, s62, 14
  s_lshl_b32 s63, s63, 7
  s_add_u32 s97, s62, s63
  s_lshl_b32 s101, s36, 11
  s_add_u32 s101, s101, 122880
  s_mov_b32 m0, s101
  s_add_u32 s62, s97, 7168
  buffer_load_dwordx4 v30, s[16:19], s97 offen lds
  buffer_load_dwordx4 v30, s[16:19], s62 offen offset:1024 lds
  s_lshr_b32 s62, s2, 2
  s_cmp_ge_u32 s62, 28
  s_cselect_b32 s52, s12, s8
  s_cselect_b32 s53, s13, s9
  s_cselect_b32 s63, 28, 0
  s_mov_b32 s55, 0x20000
  s_sub_u32 s63, s62, s63
  s_cmp_ge_u32 s62, 56
  s_cselect_b32 s54, 0, 1835008
  s_lshl_b32 s63, s63, 7
  s_and_b32 s62, s2, 3
  s_mul_i32 s62, s62, 458752
  s_add_u32 s62, s62, s63
  v_lshrrev_b32 v8, 3, v0
  v_mul_u32_u24 v8, 3584, v8
  v_and_b32 v9, 7, v0
  v_lshl_add_u32 v8, v9, 4, v8
  buffer_load_dwordx4 v[148:151], v8, s[52:55], s62 offen
  s_add_u32 s62, s62, 114688
  buffer_load_dwordx4 v[152:155], v8, s[52:55], s62 offen
  s_add_u32 s62, s62, 114688
  buffer_load_dwordx4 v[156:159], v8, s[52:55], s62 offen
  s_add_u32 s62, s62, 114688
  buffer_load_dwordx4 v[160:163], v8, s[52:55], s62 offen
  s_lshr_b32 s62, s36, 1
  s_cmp_lg_u32 s62, 0
  s_cselect_b32 s40, s12, s8
  s_cselect_b32 s41, s13, s9
  v_lshrrev_b32 v8, 3, v1
  v_bfe_u32 v9, v1, 1, 2
  v_and_b32 v17, 2, v8
  v_xor_b32 v9, v9, v17
  v_xor_b32 v9, s62, v9
  v_and_b32 v17, 1, v1
  v_lshlrev_b32 v17, 4, v17
  v_lshl_add_u32 v9, v9, 5, v17
  s_and_b32 s63, s60, 3
  s_lshl_b32 s42, s63, 5
  v_add_u32 v9, s42, v9
  v_mul_u32_u24 v18, 43, v1
  v_lshrrev_b32 v18, 8, v18
  v_mul_u32_u24 v19, 6, v18
  v_sub_u32 v19, v1, v19
  v_lshrrev_b32 v20, 1, v19
  v_cmp_le_u32 vcc, s63, v20
  v_lshlrev_b32 v19, 4, v19
  v_add_u32 v21, 128, v19
  v_cndmask_b32 v19, v19, v21, vcc
  s_or_b32 s100, s56, s59
  s_cmp_lg_u32 s56, 0
  s_cselect_b32 s96, 0, s59
  s_and_b32 s62, s36, 1
  s_lshl_b32 s62, s62, 3
  s_mul_i32 s43, s60, 224
  s_movk_i32 s51, 3584
  v_add_u32 v20, s62, v8
  v_add_u32 v21, s43, v9
  v_mad_u32_u24 v24, v20, s51, v21
  v_add_u32 v22, s96, v20
  v_cmp_eq_u32 vcc, 0, v20
  s_cmp_lg_u32 s56, 0
  s_cselect_b64 vcc, vcc, 0
  v_mov_b32 v23, 0x100
  v_cndmask_b32 v22, v22, v23, vcc
  v_mad_u32_u24 v25, v22, s51, v21
  v_add_u32 v22, s100, v20
  v_add_u32 v22, 496, v22
  v_and_b32 v22, 511, v22
  v_mad_u32_u24 v26, v22, s51, v21
  s_movk_i32 s51, 3584
  v_add_u32 v20, s62, v18
  v_add_u32 v21, s43, v19
  v_mad_u32_u24 v27, v20, s51, v21
  v_add_u32 v22, s96, v20
  v_cmp_eq_u32 vcc, 0, v20
  s_cmp_lg_u32 s56, 0
  s_cselect_b64 vcc, vcc, 0
  v_mov_b32 v23, 0x100
  v_cndmask_b32 v22, v22, v23, vcc
  v_mad_u32_u24 v28, v22, s51, v21
  v_add_u32 v22, s100, v20
  v_add_u32 v22, 496, v22
  v_and_b32 v22, 511, v22
  v_mad_u32_u24 v29, v22, s51, v21
  s_mul_i32 s96, s96, 3584
  s_mul_i32 s100, s100, 3584
  s_add_u32 s100, s100, 917504
  s_mov_b32 s52, s40
  s_mov_b32 s53, s41
  s_mov_b32 s54, 1835008
  s_and_b32 s62, s36, 1
  s_lshl_b32 s63, s59, 1
  s_add_u32 s62, s62, s63
  s_mul_i32 s79, s62, 458752
  s_add_u32 s79, s79, s43
  s_add_u32 s79, s79, s42
  s_movk_i32 s62, 128
  s_cmp_eq_u32 s42, 96
  s_cselect_b32 s62, -128, s62
  s_add_u32 s82, s79, s62
  v_mul_u32_u24 v254, 3584, v1
  s_lshr_b32 s62, s36, 1
  s_and_b32 s63, s36, 1
  s_lshl_b32 s44, s62, 11
  s_lshl_b32 s45, s63, 10
  s_add_u32 s44, s44, s45
  s_mul_i32 s45, s62, 2176
  s_mul_i32 s63, s63, 768
  s_add_u32 s45, s45, s63
  s_add_u32 m0, s44, 0
  s_nop 0
  buffer_load_dwordx4 v25, s[52:55], 0 offen lds
  v_lshrrev_b32 v8, 2, v2
  v_and_b32 v9, 2, v2
  v_cmp_eq_u32 vcc, 0, v8
  v_lshlrev_b32 v17, 1, v9
  s_nop 0
  v_cndmask_b32 v17, v8, v17, vcc
  v_cndmask_b32 v9, v9, 0, vcc
  v_cvt_f32_u32 v9, v9
  v_sub_f32 v9, 1.0, v9
  v_and_b32 v18, 1, v2
  v_cvt_f32_u32 v18, v18
  v_mul_f32 v18, 0x3e800000, v18
  v_lshlrev_b32 v19, 9, v3
  v_add_u32 v19, s2, v19
  v_mul_u32_u24 v20, v17, v19
  v_cvt_f32_u32 v20, v20
  v_mul_f32 v20, 0x3a000000, v20
  v_add_f32 v20, v20, v18
  v_cos_f32 v21, v20
  v_sin_f32 v20, v20
  v_add_u32 v19, 0x100, v19
  v_mul_f32 v20, v20, v9
  v_cvt_pk_f16_f32 v6, v21, v20
  v_mul_u32_u24 v20, v17, v19
  v_cvt_f32_u32 v20, v20
  v_mul_f32 v20, 0x3a000000, v20
  v_add_f32 v20, v20, v18
  v_cos_f32 v21, v20
  v_sin_f32 v20, v20
  v_add_u32 v19, 0x100, v19
  v_mul_f32 v20, v20, v9
  v_cvt_pk_f16_f32 v7, v21, v20
  v_cmp_eq_u32 s[64:65], 0, v2
  v_cmp_eq_u32 s[66:67], 0, v3
  s_lshl_b32 s62, s36, 7
  s_sub_u32 s63, 512, s62
  s_cmp_lt_u32 s36, 2
  s_cselect_b32 s40, s62, s63
  s_cselect_b32 s41, 1, -1
  s_cselect_b32 s42, 32, 4294967056
  s_add_u32 s42, s42, s62
  v_mul_i32_i24 v8, s41, v2
  v_add_u32 v8, s40, v8
  s_lshl_b32 s41, s41, 5
  v_mov_b32 v9, s42
  v_lshlrev_b32 v17, 11, v3
  v_add_u32 v17, 131072, v17
  v_cndmask_b32 v18, v8, v9, s[64:65]
  v_and_b32 v19, 255, v18
  v_sub_u32 v20, 0x200, v18
  v_add_u32 v21, 0x100, v19
  v_cndmask_b32 v18, v18, v19, s[66:67]
  v_cndmask_b32 v20, v20, v21, s[66:67]
  v_lshl_add_u32 v46, v18, 2, v17
  v_lshl_add_u32 v47, v20, 2, v17
  v_add_u32 v8, s41, v8
  s_add_u32 s3, s96, 57344
  s_add_u32 m0, s44, 4096
  s_nop 0
  buffer_load_dwordx4 v24, s[52:55], s3 offen lds
  v_add_u32 v9, 32, v9
  v_cndmask_b32 v18, v8, v9, s[64:65]
  v_and_b32 v19, 255, v18
  v_sub_u32 v20, 0x200, v18
  v_add_u32 v21, 0x100, v19
  v_cndmask_b32 v18, v18, v19, s[66:67]
  v_cndmask_b32 v20, v20, v21, s[66:67]
  v_lshl_add_u32 v48, v18, 2, v17
  v_lshl_add_u32 v49, v20, 2, v17
  v_add_u32 v8, s41, v8
  v_add_u32 v9, 32, v9
  v_cndmask_b32 v18, v8, v9, s[64:65]
  v_and_b32 v19, 255, v18
  v_sub_u32 v20, 0x200, v18
  v_add_u32 v21, 0x100, v19
  v_cndmask_b32 v18, v18, v19, s[66:67]
  v_cndmask_b32 v20, v20, v21, s[66:67]
  v_lshl_add_u32 v50, v18, 2, v17
  v_lshl_add_u32 v51, v20, 2, v17
  v_add_u32 v8, s41, v8
  v_add_u32 v9, 32, v9
  v_cndmask_b32 v18, v8, v9, s[64:65]
  v_and_b32 v19, 255, v18
  v_sub_u32 v20, 0x200, v18
  v_add_u32 v21, 0x100, v19
  v_cndmask_b32 v18, v18, v19, s[66:67]
  v_cndmask_b32 v20, v20, v21, s[66:67]
  v_lshl_add_u32 v52, v18, 2, v17
  v_lshl_add_u32 v53, v20, 2, v17
  s_lshl_b32 s62, s36, 11
  s_add_u32 s63, s62, 131072
  v_lshlrev_b32 v8, 8, v3
  v_lshl_add_u32 v54, v2, 3, v8
  v_add_u32 v54, s63, v54
  s_lshl_b32 s63, s36, 6
  s_add_u32 s63, s63, s62
  s_add_u32 s63, s63, 147456
  v_lshl_add_u32 v55, v2, 2, v8
  v_add_u32 v55, s63, v55
  v_mul_u32_u24 v56, 2112, v3
  v_lshl_add_u32 v56, v2, 2, v56
  s_lshl_b32 s63, s36, 8
  s_add_u32 s63, s63, 147456
  v_add_u32 v56, s63, v56
  s_add_u32 s62, s62, 131072
  v_add_u32 v57, s62, v144
  v_mov_b32 v8, 0x42000000
  v_cndmask_b32 v58, 0, v8, s[64:65]
  v_mov_b32 v59, 0x3b000000
  v_mov_b32 v60, 0x3f803f80
  v_lshlrev_b32 v8, 2, v1
  v_add_u32 v8, 156160, v8
  v_mov_b32 v9, 0
  ds_write_b32 v8, v9
  v_add_u32 v8, 256, v8
  v_cndmask_b32 v45, v17, v8, s[66:67]
  s_and_b32 s62, s38, 7
  s_bfe_u32 s63, s38, 0x10003
  s_add_u32 s3, s96, 114688
  s_add_u32 m0, s44, 8192
  s_nop 0
  buffer_load_dwordx4 v24, s[52:55], s3 offen lds
  s_cmp_lg_u32 s56, 0
  s_cselect_b32 s68, s62, s60
  s_cselect_b32 s69, s63, s59
  s_cselect_b32 s70, s59, 0
  s_cselect_b32 s71, s37, 0
  s_lshl_b32 s71, s71, 8
  s_lshl_b32 s62, s68, 5
  s_add_u32 s71, s71, s62
  s_lshr_b32 s62, s36, 1
  s_lshl_b32 s63, s69, 1
  s_add_u32 s62, s62, s63
  s_lshl_b32 s62, s62, 5
  v_add_u32 v10, s62, v4
  v_xor_b32 v11, 32, v10
  v_add_u32 v12, s58, v10
  v_lshl_add_u32 v12, v12, 3, s57
  v_sub_u32 v8, 0x800, v12
  v_cmp_eq_u32 vcc, 0, v12
  v_mov_b32 v9, 0x400
  s_nop 0
  v_cndmask_b32 v8, v8, v9, vcc
  s_cmp_lg_u32 s70, 0
  s_cselect_b64 vcc, -1, 0
  v_cndmask_b32 v12, v12, v8, vcc
  v_add_u32 v13, s58, v11
  v_lshl_add_u32 v13, v13, 3, s57
  v_sub_u32 v8, 0x800, v13
  v_cmp_eq_u32 vcc, 0, v13
  v_mov_b32 v9, 0x400
  s_nop 0
  v_cndmask_b32 v8, v8, v9, vcc
  s_cmp_lg_u32 s70, 0
  s_cselect_b64 vcc, -1, 0
  v_cndmask_b32 v13, v13, v8, vcc
  s_and_b32 s62, s36, 1
  s_lshl_b32 s62, s62, 1
  s_lshl_b32 s63, s68, 2
  s_add_u32 s62, s62, s63
  v_add_u32 v14, s62, v5
  v_sub_u32 v15, 63, v14
  v_sub_u32 v16, 0x800, v12
  v_and_b32 v16, 0x7ff, v16
  v_lshlrev_b32 v17, 10, v12
  v_lshlrev_b32 v61, 10, v16
  v_lshl_add_u32 v143, v14, 4, v17
  v_lshl_add_u32 v145, v15, 4, v61
  v_add_u32 v145, 2, v145
  v_cmp_eq_u32 s[98:99], 0, v14
  s_lshl_b32 s62, s56, 9
  v_add_u32 v147, s62, v17
  s_lshl_b32 s62, s37, 1
  s_add_u32 s62, s62, s70
  v_mov_b32 v8, s62
  v_xor_b32 v9, 1, v8
  v_cmp_eq_u32 vcc, v12, v16
  v_lshrrev_b32 v19, 5, v10
  v_lshlrev_b32 v17, 4, v4
  v_lshl_add_u32 v20, v19, 13, v17
  v_lshl_add_u32 v17, v19, 15, v17
  v_cndmask_b32 v9, v9, v8, vcc
  v_lshl_add_u32 v138, v14, 9, v17
  s_add_u32 s3, s96, 172032
  s_add_u32 m0, s44, 12288
  s_nop 0
  buffer_load_dwordx4 v24, s[52:55], s3 offen lds
  v_lshl_add_u32 v139, v15, 9, v17
  v_lshl_add_u32 v138, v8, 17, v138
  v_lshl_add_u32 v139, v9, 17, v139
  v_cmp_eq_u32 vcc, 0, v5
  s_lshl_b32 s63, s56, 3
  v_mov_b32 v18, s63
  v_cndmask_b32 v8, v9, v8, vcc
  v_cndmask_b32 v18, v18, 0, vcc
  v_add_u32 v18, s68, v18
  v_lshl_add_u32 v140, v8, 15, v20
  v_lshl_add_u32 v140, v18, 9, v140
  s_and_b32 s62, s36, 1
  s_lshl_b32 s63, s62, 3
  v_add_u32 v140, s63, v140
  s_lshl_b32 s62, s62, 4
  v_xor_b32 v8, s62, v4
  v_and_b32 v9, 19, v8
  v_bfe_u32 v17, v8, 2, 1
  v_lshl_or_b32 v9, v17, 3, v9
  v_bfe_u32 v17, v8, 3, 1
  v_lshl_or_b32 v9, v17, 2, v9
  v_add_u32 v9, s71, v9
  v_lshlrev_b32 v9, 2, v9
  v_lshl_add_u32 v141, v5, 13, v9
  v_add_u32 v142, 0x1000, v141
  v_mov_b32 v62, v12
  v_mov_b32 v63, v13
  s_lshl_b32 s62, s69, 1
  s_lshr_b32 s63, s36, 1
  s_add_u32 s62, s62, s63
  s_lshl_b32 s62, s62, 4
  s_lshl_b32 s63, s70, 3
  s_add_u32 s63, s63, s68
  s_add_u32 s62, s62, s63
  s_lshl_b32 s62, s62, 1
  s_and_b32 s63, s36, 1
  s_add_u32 s62, s62, s63
  s_lshl_b32 s63, s37, 7
  s_add_u32 s62, s62, s63
  s_lshl_b32 s78, s62, 6
  v_bfe_u32 v8, v1, 2, 2
  v_lshl_add_u32 v8, v5, 3, v8
  v_lshlrev_b32 v8, 7, v8
  v_and_b32 v9, 1, v1
  v_lshl_add_u32 v8, v9, 5, v8
  v_bfe_u32 v9, v1, 4, 1
  v_lshl_add_u32 v8, v9, 4, v8
  v_bfe_u32 v9, v1, 1, 1
  v_lshl_add_u32 v8, v9, 3, v8
  v_bfe_u32 v9, v1, 3, 1
  s_and_b32 s62, s36, 1
  v_xor_b32 v9, s62, v9
  v_lshl_add_u32 v31, v9, 6, v8
  v_xor_b32 v32, 64, v31
  v_add_u32 v33, s101, v31
  v_add_u32 v34, s101, v32
  s_lshl_b32 s62, s62, 10
  v_add_u32 v31, s62, v144
  v_xor_b32 v32, 0x400, v31
  s_waitcnt vmcnt(10)
  s_barrier
  v_add_u32 v8, 139264, v144
  s_add_u32 s3, s96, 229376
  s_add_u32 m0, s44, 16384
  s_nop 0
  buffer_load_dwordx4 v24, s[52:55], s3 offen lds
  ds_read_b64_tr_b16 v[196:197], v54 offset:0
  ds_read_b64_tr_b16 v[198:199], v54 offset:128
  ds_read_b64_tr_b16 v[200:201], v54 offset:1024
  ds_read_b64_tr_b16 v[202:203], v54 offset:1152
  ds_read_b128 v[164:167], v8 offset:0
  ds_read_b128 v[168:171], v8 offset:1024
  ds_read_b128 v[172:175], v8 offset:2048
  ds_read_b128 v[176:179], v8 offset:3072
  ds_read_b128 v[180:183], v8 offset:4096
  ds_read_b128 v[184:187], v8 offset:5120
  ds_read_b128 v[188:191], v8 offset:6144
  ds_read_b128 v[192:195], v8 offset:7168
  s_waitcnt lgkmcnt(6)
  v_mfma_f32_16x16x32_bf16 v[204:207], v[196:199], v[164:167], 0
  v_mfma_f32_16x16x32_bf16 v[208:211], v[196:199], v[168:171], 0
  s_waitcnt lgkmcnt(6)
  v_mfma_f32_16x16x32_bf16 v[212:215], v[200:203], v[164:167], 0
  v_mfma_f32_16x16x32_bf16 v[216:219], v[200:203], v[168:171], 0
  v_dot2_f32_bf16 v8, v196, v60, 0
  v_dot2_f32_bf16 v9, v196, v196, 0
  v_dot2_f32_bf16 v10, v200, v60, 0
  v_dot2_f32_bf16 v11, v200, v200, 0
  v_dot2_f32_bf16 v8, v197, v60, v8
  v_dot2_f32_bf16 v9, v197, v197, v9
  v_dot2_f32_bf16 v10, v201, v60, v10
  v_dot2_f32_bf16 v11, v201, v201, v11
  v_dot2_f32_bf16 v8, v198, v60, v8
  v_dot2_f32_bf16 v9, v198, v198, v9
  v_dot2_f32_bf16 v10, v202, v60, v10
  v_dot2_f32_bf16 v11, v202, v202, v11
  v_dot2_f32_bf16 v8, v199, v60, v8
  v_dot2_f32_bf16 v9, v199, v199, v9
  v_dot2_f32_bf16 v10, v203, v60, v10
  v_dot2_f32_bf16 v11, v203, v203, v11
  s_nop 0
  v_permlane16_swap_b32 v8, v9
  s_nop 0
  v_permlane16_swap_b32 v10, v11
  v_add_f32 v8, v8, v9
  v_add_f32 v10, v10, v11
  s_nop 1
  v_permlane32_swap_b32 v8, v10
  v_add_f32 v8, v8, v10
  s_add_u32 s3, s96, 286720
  s_add_u32 m0, s44, 20480
  s_nop 0
  buffer_load_dwordx4 v24, s[52:55], s3 offen lds
  v_add_f32_dpp v8, v8, v8 quad_perm:[1,0,3,2] row_mask:0xf bank_mask:0xf
  s_nop 1
  v_add_f32_dpp v8, v8, v8 quad_perm:[2,3,0,1] row_mask:0xf bank_mask:0xf
  s_nop 1
  v_add_f32_dpp v8, v8, v8 row_half_mirror row_mask:0xf bank_mask:0xf
  s_nop 1
  v_add_f32_dpp v8, v8, v8 row_mirror row_mask:0xf bank_mask:0xf
  s_nop 0
  v_readlane_b32 s46, v8, 0
  v_readlane_b32 s47, v8, 16
  v_readlane_b32 s48, v8, 32
  v_readlane_b32 s49, v8, 48
  v_mul_f32 v8, s46, v59
  v_mul_f32 v10, s47, v59
  v_mul_f32 v9, s48, v59
  v_mul_f32 v12, s49, v59
  v_fma_f32 v10, -v8, v8, v10
  v_fma_f32 v12, -v9, v9, v12
  v_add_f32 v10, 0x3727c5ac, v10
  v_add_f32 v12, 0x3727c5ac, v12
  v_rsq_f32 v10, v10
  v_mul_f32 v8, v8, v58
  v_rsq_f32 v12, v12
  v_mul_f32 v9, v9, v58
  s_waitcnt lgkmcnt(0)
  v_sub_f32 v204, v204, v8
  v_sub_f32 v205, v205, v8
  v_sub_f32 v206, v206, v8
  v_sub_f32 v207, v207, v8
  v_pk_mul_f32 v[220:221], v[172:173], v[10:11] op_sel_hi:[1,0]
  v_pk_mul_f32 v[222:223], v[174:175], v[10:11] op_sel_hi:[1,0]
  v_pk_mul_f32 v[224:225], v[176:177], v[10:11] op_sel_hi:[1,0]
  v_pk_mul_f32 v[226:227], v[178:179], v[10:11] op_sel_hi:[1,0]
  v_sub_f32 v212, v212, v9
  v_sub_f32 v213, v213, v9
  v_sub_f32 v214, v214, v9
  v_sub_f32 v215, v215, v9
  v_pk_mul_f32 v[228:229], v[172:173], v[12:13] op_sel_hi:[1,0]
  v_pk_mul_f32 v[230:231], v[174:175], v[12:13] op_sel_hi:[1,0]
  v_pk_mul_f32 v[232:233], v[176:177], v[12:13] op_sel_hi:[1,0]
  v_pk_mul_f32 v[234:235], v[178:179], v[12:13] op_sel_hi:[1,0]
  v_pk_mul_f32 v[14:15], v[204:205], v[220:221]
  v_pk_mul_f32 v[16:17], v[208:209], v[220:221]
  v_pk_mul_f32 v[18:19], v[206:207], v[222:223]
  v_pk_mul_f32 v[20:21], v[210:211], v[222:223]
  v_pk_fma_f32 v[14:15], v[208:209], v[224:225], v[14:15]
  v_pk_fma_f32 v[16:17], v[204:205], v[224:225], v[16:17] neg_lo:[1,0,0] neg_hi:[1,0,0]
  v_pk_fma_f32 v[18:19], v[210:211], v[226:227], v[18:19]
  v_pk_fma_f32 v[20:21], v[206:207], v[226:227], v[20:21] neg_lo:[1,0,0] neg_hi:[1,0,0]
  v_cvt_pk_f16_f32 v236, v14, v16
  v_cvt_pk_f16_f32 v237, v15, v17
  v_cvt_pk_f16_f32 v238, v18, v20
  v_cvt_pk_f16_f32 v239, v19, v21
  s_nop 1
  v_mfma_f32_16x16x32_f16 v[196:199], v[180:183], v[236:239], 0
  v_mfma_f32_16x16x32_f16 v[204:207], v[184:187], v[236:239], 0
  v_mfma_f32_16x16x32_f16 v[244:247], v[188:191], v[236:239], 0
  s_add_u32 s3, s96, 344064
  s_add_u32 m0, s44, 24576
  s_nop 0
  buffer_load_dwordx4 v24, s[52:55], s3 offen lds
  v_mfma_f32_16x16x32_f16 v[248:251], v[192:195], v[236:239], 0
  v_pk_mul_f32 v[14:15], v[212:213], v[228:229]
  v_pk_mul_f32 v[16:17], v[216:217], v[228:229]
  v_pk_mul_f32 v[18:19], v[214:215], v[230:231]
  v_pk_mul_f32 v[20:21], v[218:219], v[230:231]
  v_pk_fma_f32 v[14:15], v[216:217], v[232:233], v[14:15]
  v_pk_fma_f32 v[16:17], v[212:213], v[232:233], v[16:17] neg_lo:[1,0,0] neg_hi:[1,0,0]
  v_pk_fma_f32 v[18:19], v[218:219], v[234:235], v[18:19]
  v_pk_fma_f32 v[20:21], v[214:215], v[234:235], v[20:21] neg_lo:[1,0,0] neg_hi:[1,0,0]
  v_cvt_pk_f16_f32 v240, v14, v16
  v_cvt_pk_f16_f32 v241, v15, v17
  v_cvt_pk_f16_f32 v242, v18, v20
  v_cvt_pk_f16_f32 v243, v19, v21
  s_nop 1
  v_mfma_f32_16x16x32_f16 v[200:203], v[180:183], v[240:243], 0
  v_mfma_f32_16x16x32_f16 v[212:215], v[184:187], v[240:243], 0
  v_mfma_f32_16x16x32_f16 v[220:223], v[188:191], v[240:243], 0
  v_mfma_f32_16x16x32_f16 v[224:227], v[192:195], v[240:243], 0
  v_cvt_pk_f16_f32 v8, v196, v204
  v_cvt_pk_f16_f32 v9, v197, v205
  v_cvt_pk_f16_f32 v10, v198, v206
  v_cvt_pk_f16_f32 v11, v199, v207
  s_nop 1
  v_cvt_pk_f16_f32 v12, v200, v212
  v_cvt_pk_f16_f32 v13, v201, v213
  v_cvt_pk_f16_f32 v14, v202, v214
  v_cvt_pk_f16_f32 v15, v203, v215
  s_mov_b64 exec, s[64:65]
  v_cvt_pk_f16_f32 v8, v244, v248
  v_cvt_pk_f16_f32 v9, v245, v249
  v_cvt_pk_f16_f32 v10, v246, v250
  v_cvt_pk_f16_f32 v11, v247, v251
  v_cvt_pk_f16_f32 v12, v220, v224
  v_cvt_pk_f16_f32 v13, v221, v225
  v_cvt_pk_f16_f32 v14, v222, v226
  v_cvt_pk_f16_f32 v15, v223, v227
  s_mov_b64 exec, -1
  v_add_u32 v17, 1024, v55
  v_mov_b32 v23, 0
  buffer_load_dword v146, v23, s[28:31], 0 offen sc1
  ds_write2_b32 v55, v8, v9 offset0:0 offset1:16
  ds_write2_b32 v55, v10, v11 offset0:32 offset1:48
  ds_write2_b32 v17, v12, v13 offset0:0 offset1:16
  ds_write2_b32 v17, v14, v15 offset0:32 offset1:48
  s_waitcnt lgkmcnt(0)
  s_barrier
  s_add_u32 s3, s96, 401408
  s_add_u32 m0, s44, 28672
  s_nop 0
  buffer_load_dwordx4 v24, s[52:55], s3 offen lds
  v_mov_b32 v16, 0
  ds_write_b32 v45, v16
  ds_read_b32 v8, v56 offset:0
  ds_read_b32 v9, v56 offset:1024
  ds_read_b32 v10, v56 offset:64
  ds_read_b32 v11, v56 offset:1088
  ds_read_b32 v12, v56 offset:128
  ds_read_b32 v13, v56 offset:1152
  ds_read_b32 v14, v56 offset:192
  ds_read_b32 v15, v56 offset:1216
  s_waitcnt lgkmcnt(6)
  v_mfma_f32_16x16x16_f16 v[196:199], v[6:7], v[8:9], 0
  s_waitcnt lgkmcnt(4)
  v_mfma_f32_16x16x16_f16 v[200:203], v[6:7], v[10:11], 0
  s_waitcnt lgkmcnt(2)
  v_mfma_f32_16x16x16_f16 v[204:207], v[6:7], v[12:13], 0
  s_waitcnt lgkmcnt(0)
  v_mfma_f32_16x16x16_f16 v[208:211], v[6:7], v[14:15], 0
  s_nop 1
  v_cvt_pk_f16_f32 v16, v196, v197
  v_cvt_pk_f16_f32 v17, v198, v199
  ds_write_b32 v46, v16
  ds_write_b32 v47, v17
  v_cvt_pk_f16_f32 v18, v200, v201
  v_cvt_pk_f16_f32 v19, v202, v203
  ds_write_b32 v48, v18
  ds_write_b32 v49, v19
  v_cvt_pk_f16_f32 v20, v204, v205
  v_cvt_pk_f16_f32 v21, v206, v207
  ds_write_b32 v50, v20
  ds_write_b32 v51, v21
  v_cvt_pk_f16_f32 v22, v208, v209
  v_cvt_pk_f16_f32 v23, v210, v211
  ds_write_b32 v52, v22
  ds_write_b32 v53, v23
  s_waitcnt lgkmcnt(0)
  s_barrier
  s_waitcnt vmcnt(13)
  ds_read_b128 v[8:11], v57
  ds_read_b128 v[12:15], v57 offset:1024
  s_lshl_b32 s62, s36, 8
  s_add_u32 s62, s62, s2
  s_lshl_b32 s62, s62, 11
  s_add_u32 s62, s62, 1048576
  s_waitcnt lgkmcnt(1)
  buffer_store_dwordx4 v[8:11], v144, s[24:27], s62 offen sc1
  s_waitcnt lgkmcnt(0)
  buffer_store_dwordx4 v[12:15], v144, s[24:27], s62 offen offset:1024 sc1
  ds_read_b64_tr_b16 v[196:197], v33
  ds_read_b64_tr_b16 v[198:199], v33 offset:512
  ds_read_b64_tr_b16 v[200:201], v34
  ds_read_b64_tr_b16 v[202:203], v34 offset:512
  s_lshl_b32 s62, s90, 11
  s_add_u32 s62, s62, 13631488
  s_waitcnt lgkmcnt(2)
  buffer_store_dwordx4 v[196:199], v31, s[24:27], s62 offen sc1
  s_waitcnt lgkmcnt(0)
  buffer_store_dwordx4 v[200:203], v32, s[24:27], s62 offen sc1
  s_waitcnt vmcnt(13)
  v_lshlrev_b32 v8, 16, v148
  v_and_b32 v9, 0xffff0000, v148
  v_lshlrev_b32 v10, 16, v149
  v_and_b32 v11, 0xffff0000, v149
  v_lshlrev_b32 v12, 16, v150
  v_and_b32 v13, 0xffff0000, v150
  v_lshlrev_b32 v14, 16, v151
  v_and_b32 v15, 0xffff0000, v151
  v_lshlrev_b32 v16, 16, v152
  v_and_b32 v17, 0xffff0000, v152
  v_pk_add_f32 v[8:9], v[8:9], v[16:17]
  v_lshlrev_b32 v16, 16, v153
  v_and_b32 v17, 0xffff0000, v153
  v_pk_add_f32 v[10:11], v[10:11], v[16:17]
  v_lshlrev_b32 v16, 16, v154
  v_and_b32 v17, 0xffff0000, v154
  v_pk_add_f32 v[12:13], v[12:13], v[16:17]
  v_lshlrev_b32 v16, 16, v155
  v_and_b32 v17, 0xffff0000, v155
  v_pk_add_f32 v[14:15], v[14:15], v[16:17]
  v_lshlrev_b32 v16, 16, v156
  v_and_b32 v17, 0xffff0000, v156
  v_pk_add_f32 v[8:9], v[8:9], v[16:17]
  v_lshlrev_b32 v16, 16, v157
  v_and_b32 v17, 0xffff0000, v157
  v_pk_add_f32 v[10:11], v[10:11], v[16:17]
  v_lshlrev_b32 v16, 16, v158
  v_and_b32 v17, 0xffff0000, v158
  v_pk_add_f32 v[12:13], v[12:13], v[16:17]
  v_lshlrev_b32 v16, 16, v159
  v_and_b32 v17, 0xffff0000, v159
  v_pk_add_f32 v[14:15], v[14:15], v[16:17]
  v_lshlrev_b32 v16, 16, v160
  v_and_b32 v17, 0xffff0000, v160
  v_pk_add_f32 v[8:9], v[8:9], v[16:17]
  v_lshlrev_b32 v16, 16, v161
  v_and_b32 v17, 0xffff0000, v161
  v_pk_add_f32 v[10:11], v[10:11], v[16:17]
  v_lshlrev_b32 v16, 16, v162
  v_and_b32 v17, 0xffff0000, v162
  v_pk_add_f32 v[12:13], v[12:13], v[16:17]
  v_lshlrev_b32 v16, 16, v163
  v_and_b32 v17, 0xffff0000, v163
  v_pk_add_f32 v[14:15], v[14:15], v[16:17]
  v_add_f32_dpp v8, v8, v8 row_ror:8 row_mask:0xf bank_mask:0xf
  v_add_f32_dpp v9, v9, v9 row_ror:8 row_mask:0xf bank_mask:0xf
  v_add_f32_dpp v10, v10, v10 row_ror:8 row_mask:0xf bank_mask:0xf
  v_add_f32_dpp v11, v11, v11 row_ror:8 row_mask:0xf bank_mask:0xf
  v_add_f32_dpp v12, v12, v12 row_ror:8 row_mask:0xf bank_mask:0xf
  v_add_f32_dpp v13, v13, v13 row_ror:8 row_mask:0xf bank_mask:0xf
  v_add_f32_dpp v14, v14, v14 row_ror:8 row_mask:0xf bank_mask:0xf
  v_add_f32_dpp v15, v15, v15 row_ror:8 row_mask:0xf bank_mask:0xf
  v_permlane16_swap_b32 v8, v12
  v_permlane16_swap_b32 v9, v13
  v_permlane16_swap_b32 v10, v14
  v_permlane16_swap_b32 v11, v15
  v_add_f32 v8, v8, v12
  v_add_f32 v9, v9, v13
  v_add_f32 v10, v10, v14
  v_add_f32 v11, v11, v15
  s_nop 0
  v_permlane32_swap_b32 v8, v10
  v_permlane32_swap_b32 v9, v11
  v_add_f32 v8, v8, v10
  v_add_f32 v9, v9, v11
  v_and_b32 v10, 7, v1
  v_lshlrev_b32 v10, 5, v10
  v_bfe_u32 v11, v1, 4, 1
  v_lshl_add_u32 v10, v11, 4, v10
  v_lshl_add_u32 v10, v5, 3, v10
  v_add_u32 v10, 156160, v10
  v_bfe_u32 v11, v1, 3, 1
  v_cmp_eq_u32 vcc, 0, v11
  s_nop 0
  s_and_saveexec_b64 s[46:47], vcc
  ds_add_f32 v10, v8
  ds_add_f32 v10, v9 offset:4
  s_mov_b64 exec, -1
  s_lshl_b32 s47, s36, 9
  s_add_u32 s47, s47, s2
  s_lshl_b32 s47, s47, 4
  s_add_u32 s47, s47, 262144
  s_waitcnt vmcnt(2)
  s_mov_b32 s62, 0
L_NP:
  v_readfirstlane_b32 s39, v146
  s_nop 0
  s_cmp_lg_u32 s39, 0
  s_cbranch_scc1 L_NPD
  s_add_u32 s62, s62, 1
  s_cmp_gt_u32 s62, 400000
  s_cbranch_scc1 L_NPD
  v_mov_b32 v23, 0
  buffer_load_dword v146, v23, s[28:31], 0 offen sc1
  s_waitcnt vmcnt(0)
  s_branch L_NP
L_NPD:
  s_mov_b64 exec, 3
  v_lshlrev_b32 v16, 12, v1
  v_mov_b32 v17, s39
  buffer_store_dword v17, v16, s[24:27], s47 offen sc1
  s_mov_b64 exec, -1
  buffer_load_dwordx4 v[128:131], v143, s[4:7], 0 offen
  buffer_load_dwordx4 v[134:137], v145, s[4:7], 0 offen
  s_cmp_eq_u64 s[98:99], 0
  s_cbranch_scc1 L_NX
  s_mov_b64 exec, s[98:99]
  buffer_load_dword v132, v147, s[4:7], 0 offen
  buffer_load_dword v133, v61, s[4:7], 0 offen
  s_mov_b64 exec, -1
L_NX:
  s_waitcnt lgkmcnt(0)
  s_barrier
  s_cmp_lg_u32 s36, 3
  s_cbranch_scc1 SK_1
  s_cmp_ge_u32 s2, 224
  s_cbranch_scc1 SK_2
  v_lshlrev_b32 v8, 2, v1
  v_add_u32 v8, 156160, v8
  ds_read_b32 v10, v8
  s_lshr_b32 s62, s2, 2
  s_lshl_b32 s62, s62, 11
  s_and_b32 s63, s2, 3
  s_lshl_b32 s63, s63, 3
  s_add_u32 s62, s62, s63
  s_add_u32 s62, s62, 0
  v_lshlrev_b32 v8, 5, v1
  v_mov_b32 v11, s39
  s_waitcnt lgkmcnt(0)
  buffer_store_dwordx2 v[10:11], v8, s[24:27], s62 offen sc1
SK_2:
SK_1:
  s_add_u32 s3, s96, 458752
  s_add_u32 m0, s44, 32768
  s_nop 0
  buffer_load_dwordx4 v24, s[52:55], s3 offen lds
  s_lshl_b32 s62, s36, 6
  v_lshlrev_b32 v17, 2, v5
  v_add_u32 v17, s62, v17
  v_cvt_f32_u32 v17, v17
  v_lshrrev_b32 v8, 3, v62
  v_cvt_f32_u32 v8, v8
  v_mul_f32 v8, 0x3b800000, v8
  v_mul_f32 v9, 0x40a00000, v8
  v_mul_f32 v18, v8, v17
  v_cos_f32 v22, v18
  v_sin_f32 v23, v18
  v_add_f32 v18, v18, v8
  v_cvt_pk_f16_f32 v64, v22, v23
  v_cos_f32 v20, v18
  v_sin_f32 v21, v18
  v_add_f32 v18, v18, v8
  v_cvt_pk_f16_f32 v65, v20, v21
  v_cos_f32 v22, v18
  v_sin_f32 v23, v18
  v_add_f32 v18, v18, v8
  v_cvt_pk_f16_f32 v66, v22, v23
  v_cos_f32 v20, v18
  v_sin_f32 v21, v18
  v_add_f32 v18, v18, v9
  v_cvt_pk_f16_f32 v67, v20, v21
  v_cos_f32 v22, v18
  v_sin_f32 v23, v18
  v_add_f32 v18, v18, v8
  v_cvt_pk_f16_f32 v68, v22, v23
  v_cos_f32 v20, v18
  v_sin_f32 v21, v18
  v_add_f32 v18, v18, v8
  v_cvt_pk_f16_f32 v69, v20, v21
  v_cos_f32 v22, v18
  v_sin_f32 v23, v18
  v_add_f32 v18, v18, v8
  v_cvt_pk_f16_f32 v70, v22, v23
  v_cos_f32 v20, v18
  v_sin_f32 v21, v18
  v_add_f32 v18, v18, v9
  v_cvt_pk_f16_f32 v71, v20, v21
  v_cos_f32 v22, v18
  s_add_u32 s3, s96, 516096
  s_add_u32 m0, s44, 36864
  s_nop 0
  buffer_load_dwordx4 v24, s[52:55], s3 offen lds
  v_sin_f32 v23, v18
  v_add_f32 v18, v18, v8
  v_cvt_pk_f16_f32 v72, v22, v23
  v_cos_f32 v20, v18
  v_sin_f32 v21, v18
  v_add_f32 v18, v18, v8
  v_cvt_pk_f16_f32 v73, v20, v21
  v_cos_f32 v22, v18
  v_sin_f32 v23, v18
  v_add_f32 v18, v18, v8
  v_cvt_pk_f16_f32 v74, v22, v23
  v_cos_f32 v20, v18
  v_sin_f32 v21, v18
  v_add_f32 v18, v18, v9
  v_cvt_pk_f16_f32 v75, v20, v21
  v_cos_f32 v22, v18
  v_sin_f32 v23, v18
  v_add_f32 v18, v18, v8
  v_cvt_pk_f16_f32 v76, v22, v23
  v_cos_f32 v20, v18
  v_sin_f32 v21, v18
  v_add_f32 v18, v18, v8
  v_cvt_pk_f16_f32 v77, v20, v21
  v_cos_f32 v22, v18
  v_sin_f32 v23, v18
  v_add_f32 v18, v18, v8
  v_cvt_pk_f16_f32 v78, v22, v23
  v_cos_f32 v20, v18
  v_sin_f32 v21, v18
  v_add_f32 v18, v18, v9
  v_cvt_pk_f16_f32 v79, v20, v21
  v_cos_f32 v22, v18
  v_sin_f32 v23, v18
  v_add_f32 v18, v18, v8
  v_cvt_pk_f16_f32 v80, v22, v23
  v_cos_f32 v20, v18
  v_sin_f32 v21, v18
  v_add_f32 v18, v18, v8
  v_cvt_pk_f16_f32 v81, v20, v21
  v_cos_f32 v22, v18
  s_add_u32 s3, s96, 573440
  s_add_u32 m0, s44, 40960
  s_nop 0
  buffer_load_dwordx4 v24, s[52:55], s3 offen lds
  v_sin_f32 v23, v18
  v_add_f32 v18, v18, v8
  v_cvt_pk_f16_f32 v82, v22, v23
  v_cos_f32 v20, v18
  v_sin_f32 v21, v18
  v_add_f32 v18, v18, v9
  v_cvt_pk_f16_f32 v83, v20, v21
  v_cos_f32 v22, v18
  v_sin_f32 v23, v18
  v_add_f32 v18, v18, v8
  v_cvt_pk_f16_f32 v84, v22, v23
  v_cos_f32 v20, v18
  v_sin_f32 v21, v18
  v_add_f32 v18, v18, v8
  v_cvt_pk_f16_f32 v85, v20, v21
  v_cos_f32 v22, v18
  v_sin_f32 v23, v18
  v_add_f32 v18, v18, v8
  v_cvt_pk_f16_f32 v86, v22, v23
  v_cos_f32 v20, v18
  v_sin_f32 v21, v18
  v_add_f32 v18, v18, v9
  v_cvt_pk_f16_f32 v87, v20, v21
  v_cos_f32 v22, v18
  v_sin_f32 v23, v18
  v_add_f32 v18, v18, v8
  v_cvt_pk_f16_f32 v88, v22, v23
  v_cos_f32 v20, v18
  v_sin_f32 v21, v18
  v_add_f32 v18, v18, v8
  v_cvt_pk_f16_f32 v89, v20, v21
  v_cos_f32 v22, v18
  v_sin_f32 v23, v18
  v_add_f32 v18, v18, v8
  v_cvt_pk_f16_f32 v90, v22, v23
  v_cos_f32 v20, v18
  v_sin_f32 v21, v18
  v_add_f32 v18, v18, v9
  v_cvt_pk_f16_f32 v91, v20, v21
  v_cos_f32 v22, v18
  s_add_u32 s3, s96, 630784
  s_add_u32 m0, s44, 45056
  s_nop 0
  buffer_load_dwordx4 v24, s[52:55], s3 offen lds
  v_sin_f32 v23, v18
  v_add_f32 v18, v18, v8
  v_cvt_pk_f16_f32 v92, v22, v23
  v_cos_f32 v20, v18
  v_sin_f32 v21, v18
  v_add_f32 v18, v18, v8
  v_cvt_pk_f16_f32 v93, v20, v21
  v_cos_f32 v22, v18
  v_sin_f32 v23, v18
  v_add_f32 v18, v18, v8
  v_cvt_pk_f16_f32 v94, v22, v23
  v_cos_f32 v20, v18
  v_sin_f32 v21, v18
  v_add_f32 v18, v18, v9
  v_cvt_pk_f16_f32 v95, v20, v21
  s_lshl_b32 s47, s90, 6
  s_waitcnt vmcnt(7)
  s_mov_b64 exec, 1
  v_mov_b32 v16, 13107200
  v_mov_b32 v17, s39
  buffer_store_dword v17, v16, s[24:27], s47 offen sc1
  s_mov_b64 exec, -1
  s_lshl_b32 s62, s36, 6
  v_lshlrev_b32 v17, 2, v5
  v_add_u32 v17, s62, v17
  v_cvt_f32_u32 v17, v17
  v_lshrrev_b32 v8, 3, v63
  v_cvt_f32_u32 v8, v8
  v_mul_f32 v8, 0x3b800000, v8
  v_mul_f32 v9, 0x40a00000, v8
  v_mul_f32 v18, v8, v17
  v_cos_f32 v22, v18
  v_sin_f32 v23, v18
  v_add_f32 v18, v18, v8
  v_cvt_pk_f16_f32 v96, v22, v23
  v_cos_f32 v20, v18
  v_sin_f32 v21, v18
  v_add_f32 v18, v18, v8
  v_cvt_pk_f16_f32 v97, v20, v21
  v_cos_f32 v22, v18
  v_sin_f32 v23, v18
  v_add_f32 v18, v18, v8
  v_cvt_pk_f16_f32 v98, v22, v23
  v_cos_f32 v20, v18
  v_sin_f32 v21, v18
  s_add_u32 s3, s96, 688128
  s_add_u32 m0, s44, 49152
  s_nop 0
  buffer_load_dwordx4 v24, s[52:55], s3 offen lds
  v_add_f32 v18, v18, v9
  v_cvt_pk_f16_f32 v99, v20, v21
  v_cos_f32 v22, v18
  v_sin_f32 v23, v18
  v_add_f32 v18, v18, v8
  v_cvt_pk_f16_f32 v100, v22, v23
  v_cos_f32 v20, v18
  v_sin_f32 v21, v18
  v_add_f32 v18, v18, v8
  v_cvt_pk_f16_f32 v101, v20, v21
  v_cos_f32 v22, v18
  v_sin_f32 v23, v18
  v_add_f32 v18, v18, v8
  v_cvt_pk_f16_f32 v102, v22, v23
  v_cos_f32 v20, v18
  v_sin_f32 v21, v18
  v_add_f32 v18, v18, v9
  v_cvt_pk_f16_f32 v103, v20, v21
  v_cos_f32 v22, v18
  v_sin_f32 v23, v18
  v_add_f32 v18, v18, v8
  v_cvt_pk_f16_f32 v104, v22, v23
  v_cos_f32 v20, v18
  v_sin_f32 v21, v18
  v_add_f32 v18, v18, v8
  v_cvt_pk_f16_f32 v105, v20, v21
  v_cos_f32 v22, v18
  v_sin_f32 v23, v18
  v_add_f32 v18, v18, v8
  v_cvt_pk_f16_f32 v106, v22, v23
  v_cos_f32 v20, v18
  v_sin_f32 v21, v18
  v_add_f32 v18, v18, v9
  v_cvt_pk_f16_f32 v107, v20, v21
  v_cos_f32 v22, v18
  v_sin_f32 v23, v18
  v_add_f32 v18, v18, v8
  v_cvt_pk_f16_f32 v108, v22, v23
  v_cos_f32 v20, v18
  v_sin_f32 v21, v18
  s_add_u32 s3, s96, 745472
  s_add_u32 m0, s44, 53248
  s_nop 0
  buffer_load_dwordx4 v24, s[52:55], s3 offen lds
  v_add_f32 v18, v18, v8
  v_cvt_pk_f16_f32 v109, v20, v21
  v_cos_f32 v22, v18
  v_sin_f32 v23, v18
  v_add_f32 v18, v18, v8
  v_cvt_pk_f16_f32 v110, v22, v23
  v_cos_f32 v20, v18
  v_sin_f32 v21, v18
  v_add_f32 v18, v18, v9
  v_cvt_pk_f16_f32 v111, v20, v21
  v_cos_f32 v22, v18
  v_sin_f32 v23, v18
  v_add_f32 v18, v18, v8
  v_cvt_pk_f16_f32 v112, v22, v23
  v_cos_f32 v20, v18
  v_sin_f32 v21, v18
  v_add_f32 v18, v18, v8
  v_cvt_pk_f16_f32 v113, v20, v21
  v_cos_f32 v22, v18
  v_sin_f32 v23, v18
  v_add_f32 v18, v18, v8
  v_cvt_pk_f16_f32 v114, v22, v23
  v_cos_f32 v20, v18
  v_sin_f32 v21, v18
  v_add_f32 v18, v18, v9
  v_cvt_pk_f16_f32 v115, v20, v21
  v_cos_f32 v22, v18
  v_sin_f32 v23, v18
  v_add_f32 v18, v18, v8
  v_cvt_pk_f16_f32 v116, v22, v23
  v_cos_f32 v20, v18
  v_sin_f32 v21, v18
  v_add_f32 v18, v18, v8
  v_cvt_pk_f16_f32 v117, v20, v21
  v_cos_f32 v22, v18
  v_sin_f32 v23, v18
  v_add_f32 v18, v18, v8
  v_cvt_pk_f16_f32 v118, v22, v23
  v_cos_f32 v20, v18
  v_sin_f32 v21, v18
  s_add_u32 s3, s96, 802816
  s_add_u32 m0, s44, 57344
  s_nop 0
  buffer_load_dwordx4 v24, s[52:55], s3 offen lds
  v_add_f32 v18, v18, v9
  v_cvt_pk_f16_f32 v119, v20, v21
  v_cos_f32 v22, v18
  v_sin_f32 v23, v18
  v_add_f32 v18, v18, v8
  v_cvt_pk_f16_f32 v120, v22, v23
  v_cos_f32 v20, v18
  v_sin_f32 v21, v18
  v_add_f32 v18, v18, v8
  v_cvt_pk_f16_f32 v121, v20, v21
  v_cos_f32 v22, v18
  v_sin_f32 v23, v18
  v_add_f32 v18, v18, v8
  v_cvt_pk_f16_f32 v122, v22, v23
  v_cos_f32 v20, v18
  v_sin_f32 v21, v18
  v_add_f32 v18, v18, v9
  v_cvt_pk_f16_f32 v123, v20, v21
  v_cos_f32 v22, v18
  v_sin_f32 v23, v18
  v_add_f32 v18, v18, v8
  v_cvt_pk_f16_f32 v124, v22, v23
  v_cos_f32 v20, v18
  v_sin_f32 v21, v18
  v_add_f32 v18, v18, v8
  v_cvt_pk_f16_f32 v125, v20, v21
  v_cos_f32 v22, v18
  v_sin_f32 v23, v18
  v_add_f32 v18, v18, v8
  v_cvt_pk_f16_f32 v126, v22, v23
  v_cos_f32 v20, v18
  v_sin_f32 v21, v18
  v_add_f32 v18, v18, v9
  v_cvt_pk_f16_f32 v127, v20, v21
  v_bfe_u32 v8, v1, 2, 2
  v_lshl_add_u32 v8, v5, 3, v8
  v_and_b32 v9, 1, v1
  v_lshlrev_b32 v9, 4, v9
  v_bfe_u32 v10, v1, 1, 1
  v_lshl_add_u32 v9, v10, 3, v9
  v_bfe_u32 v10, v1, 4, 1
  v_lshl_add_u32 v11, v8, 7, v9
  v_lshl_add_u32 v11, v10, 11, v11
  s_add_u32 s3, s96, 860160
  s_add_u32 m0, s44, 61440
  s_nop 0
  buffer_load_dwordx4 v24, s[52:55], s3 offen lds
  v_bfe_u32 v12, v1, 3, 1
  v_lshl_add_u32 v12, v12, 1, v10
  v_xor_b32 v13, 0, v12
  v_lshl_add_u32 v35, v13, 5, v11
  v_xor_b32 v13, 1, v12
  v_lshl_add_u32 v36, v13, 5, v11
  v_xor_b32 v13, 2, v12
  v_lshl_add_u32 v37, v13, 5, v11
  v_xor_b32 v13, 3, v12
  v_lshl_add_u32 v38, v13, 5, v11
  v_mul_u32_u24 v8, 96, v8
  v_mul_u32_u24 v13, 2176, v10
  v_add3_u32 v40, v8, v9, v13
  v_add_u32 v39, 0x20000, v40
  v_lshlrev_b32 v8, 4, v4
  v_lshl_add_u32 v45, v5, 9, v8
  s_lshl_b32 s62, s36, 15
  v_add_u32 v41, s62, v45
  s_mul_i32 s62, s36, 114688
  v_add_u32 v45, s62, v45
  s_lshl_b32 s62, s36, 13
  v_lshl_add_u32 v42, v5, 12, v8
  v_add_u32 v42, s62, v42
  v_and_b32 v8, 3, v1
  v_bfe_u32 v9, v1, 2, 1
  v_lshl_add_u32 v8, v9, 3, v8
  v_bfe_u32 v9, v1, 3, 1
  v_lshl_add_u32 v8, v9, 2, v8
  v_mul_u32_u24 v9, 1792, v10
  v_add_u32 v8, v8, v9
  v_lshlrev_b32 v8, 5, v8
  v_lshl_add_u32 v43, v5, 4, v8
  s_and_b32 s63, s60, 3
  s_mul_i32 s62, s60, 7
  s_add_u32 s40, s62, s63
  s_add_u32 s40, s40, 0
  s_add_u32 s41, s62, s63
  s_add_u32 s41, s41, 1
  s_add_u32 s42, s62, s63
  s_add_u32 s42, s42, 2
  s_add_u32 s43, s62, s63
  s_add_u32 s43, s43, 3
  s_cmp_le_u32 s63, 0
  s_cselect_b32 s68, 4, 0
  s_add_u32 s68, s68, s62
  s_cmp_le_u32 s63, 1
  s_cselect_b32 s69, 5, 1
  s_add_u32 s69, s69, s62
  s_cmp_le_u32 s63, 2
  s_cselect_b32 s70, 6, 2
  s_add_u32 s70, s70, s62
  s_mul_i32 s71, s61, 458752
  s_add_u32 s71, s71, 5242880
  s_lshl_b32 s63, s37, 2
  s_add_u32 s63, s63, s36
  s_lshl_b32 s63, s63, 10
  s_add_u32 s63, s63, 262144
  v_lshlrev_b32 v12, 4, v1
  s_mov_b32 s62, 0
POLL_3:
  buffer_load_dword v8, v12, s[24:27], s63 offen sc1
  s_add_u32 s62, s62, 1
  s_waitcnt vmcnt(0)
  v_cmp_ne_u32 vcc, s39, v8
  s_cmp_gt_u32 s62, 400000
  s_cbranch_scc1 PDONE_4
  s_cbranch_vccz PDONE_4
  s_branch POLL_3
PDONE_4:
  s_cmp_lg_u32 s56, 0
  s_cselect_b32 s62, 0, s57
  s_lshl_b32 s62, s62, 2
  s_add_u32 s62, s62, s36
  s_lshl_b32 s62, s62, 17
  s_add_u32 s62, s62, 1048576
  buffer_load_dword v164, v141, s[24:27], s62 offen offset:0 sc1
  buffer_load_dword v165, v141, s[24:27], s62 offen offset:2048 sc1
  buffer_load_dword v166, v142, s[24:27], s62 offen offset:0 sc1
  buffer_load_dword v167, v142, s[24:27], s62 offen offset:2048 sc1
  s_add_u32 s62, s62, 16384
  buffer_load_dword v168, v141, s[24:27], s62 offen offset:0 sc1
  buffer_load_dword v169, v141, s[24:27], s62 offen offset:2048 sc1
  buffer_load_dword v170, v142, s[24:27], s62 offen offset:0 sc1
  buffer_load_dword v171, v142, s[24:27], s62 offen offset:2048 sc1
  s_add_u32 s62, s62, 16384
  buffer_load_dword v172, v141, s[24:27], s62 offen offset:0 sc1
  buffer_load_dword v173, v141, s[24:27], s62 offen offset:2048 sc1
  buffer_load_dword v174, v142, s[24:27], s62 offen offset:0 sc1
  buffer_load_dword v175, v142, s[24:27], s62 offen offset:2048 sc1
  s_add_u32 s62, s62, 16384
  buffer_load_dword v176, v141, s[24:27], s62 offen offset:0 sc1
  buffer_load_dword v177, v141, s[24:27], s62 offen offset:2048 sc1
  buffer_load_dword v178, v142, s[24:27], s62 offen offset:0 sc1
  buffer_load_dword v179, v142, s[24:27], s62 offen offset:2048 sc1
  s_add_u32 s62, s62, 16384
  buffer_load_dword v180, v141, s[24:27], s62 offen offset:0 sc1
  buffer_load_dword v181, v141, s[24:27], s62 offen offset:2048 sc1
  buffer_load_dword v182, v142, s[24:27], s62 offen offset:0 sc1
  buffer_load_dword v183, v142, s[24:27], s62 offen offset:2048 sc1
  s_add_u32 s62, s62, 16384
  buffer_load_dword v184, v141, s[24:27], s62 offen offset:0 sc1
  buffer_load_dword v185, v141, s[24:27], s62 offen offset:2048 sc1
  buffer_load_dword v186, v142, s[24:27], s62 offen offset:0 sc1
  buffer_load_dword v187, v142, s[24:27], s62 offen offset:2048 sc1
  s_add_u32 s62, s62, 16384
  buffer_load_dword v188, v141, s[24:27], s62 offen offset:0 sc1
  buffer_load_dword v189, v141, s[24:27], s62 offen offset:2048 sc1
  buffer_load_dword v190, v142, s[24:27], s62 offen offset:0 sc1
  buffer_load_dword v191, v142, s[24:27], s62 offen offset:2048 sc1
  s_add_u32 s62, s62, 16384
  buffer_load_dword v192, v141, s[24:27], s62 offen offset:0 sc1
  buffer_load_dword v193, v141, s[24:27], s62 offen offset:2048 sc1
  buffer_load_dword v194, v142, s[24:27], s62 offen offset:0 sc1
  buffer_load_dword v195, v142, s[24:27], s62 offen offset:2048 sc1
  s_add_u32 s3, s100, 0
  s_add_u32 m0, s44, 65536
  s_nop 0
  buffer_load_dwordx4 v24, s[52:55], s3 offen lds
  s_waitcnt vmcnt(29)
  v_mfma_f32_32x32x16_f16 v[196:211], v[164:167], v[64:67], 0
  v_mfma_f32_32x32x16_f16 v[212:227], v[164:167], v[96:99], 0
  s_add_u32 s3, s100, 57344
  s_add_u32 m0, s44, 69632
  s_nop 0
  buffer_load_dwordx4 v24, s[52:55], s3 offen lds
  s_waitcnt vmcnt(26)
  v_mfma_f32_32x32x16_f16 v[196:211], v[168:171], v[68:71], v[196:211]
  v_mfma_f32_32x32x16_f16 v[212:227], v[168:171], v[100:103], v[212:227]
  s_add_u32 s3, s100, 114688
  s_add_u32 m0, s44, 73728
  s_nop 0
  buffer_load_dwordx4 v24, s[52:55], s3 offen lds
  s_waitcnt vmcnt(23)
  v_mfma_f32_32x32x16_f16 v[196:211], v[172:175], v[72:75], v[196:211]
  v_mfma_f32_32x32x16_f16 v[212:227], v[172:175], v[104:107], v[212:227]
  s_add_u32 s3, s100, 172032
  s_add_u32 m0, s44, 77824
  s_nop 0
  buffer_load_dwordx4 v24, s[52:55], s3 offen lds
  s_waitcnt vmcnt(20)
  v_mfma_f32_32x32x16_f16 v[196:211], v[176:179], v[76:79], v[196:211]
  v_mfma_f32_32x32x16_f16 v[212:227], v[176:179], v[108:111], v[212:227]
  s_add_u32 s3, s100, 229376
  s_add_u32 m0, s44, 81920
  s_nop 0
  buffer_load_dwordx4 v24, s[52:55], s3 offen lds
  s_waitcnt vmcnt(17)
  v_mfma_f32_32x32x16_f16 v[196:211], v[180:183], v[80:83], v[196:211]
  v_mfma_f32_32x32x16_f16 v[212:227], v[180:183], v[112:115], v[212:227]
  s_add_u32 s3, s100, 286720
  s_add_u32 m0, s44, 86016
  s_nop 0
  buffer_load_dwordx4 v24, s[52:55], s3 offen lds
  s_waitcnt vmcnt(14)
  v_mfma_f32_32x32x16_f16 v[196:211], v[184:187], v[84:87], v[196:211]
  v_mfma_f32_32x32x16_f16 v[212:227], v[184:187], v[116:119], v[212:227]
  s_add_u32 s3, s100, 344064
  s_add_u32 m0, s44, 90112
  s_nop 0
  buffer_load_dwordx4 v24, s[52:55], s3 offen lds
  s_waitcnt vmcnt(11)
  v_mfma_f32_32x32x16_f16 v[196:211], v[188:191], v[88:91], v[196:211]
  v_mfma_f32_32x32x16_f16 v[212:227], v[188:191], v[120:123], v[212:227]
  s_add_u32 s3, s100, 401408
  s_add_u32 m0, s44, 94208
  s_nop 0
  buffer_load_dwordx4 v24, s[52:55], s3 offen lds
  s_waitcnt vmcnt(8)
  v_mfma_f32_32x32x16_f16 v[196:211], v[192:195], v[92:95], v[196:211]
  v_mfma_f32_32x32x16_f16 v[212:227], v[192:195], v[124:127], v[212:227]
  s_add_u32 s3, s100, 458752
  s_add_u32 m0, s44, 98304
  s_nop 0
  buffer_load_dwordx4 v24, s[52:55], s3 offen lds
  s_xor_b32 s62, s36, 1
  s_mul_i32 s62, s62, 6144
  s_add_u32 s62, s62, 131072
  v_add_u32 v8, s62, v144
  s_xor_b32 s62, s36, 2
  s_mul_i32 s62, s62, 6144
  s_add_u32 s62, s62, 133120
  v_add_u32 v9, s62, v144
  s_xor_b32 s62, s36, 3
  s_mul_i32 s62, s62, 6144
  s_add_u32 s62, s62, 135168
  s_add_u32 s3, s100, 516096
  s_add_u32 m0, s44, 102400
  s_nop 0
  buffer_load_dwordx4 v24, s[52:55], s3 offen lds
  v_add_u32 v10, s62, v144
  s_mul_i32 s62, s36, 6144
  s_add_u32 s62, s62, 131072
  v_add_u32 v11, s62, v144
  ds_write_b128 v8, v[204:207]
  ds_write_b128 v8, v[208:211] offset:1024
  ds_write_b128 v9, v[212:215]
  ds_write_b128 v9, v[216:219] offset:1024
  s_add_u32 s3, s100, 573440
  s_add_u32 m0, s44, 106496
  s_nop 0
  buffer_load_dwordx4 v24, s[52:55], s3 offen lds
  ds_write_b128 v10, v[220:223]
  ds_write_b128 v10, v[224:227] offset:1024
  v_cndmask_b32 v132, v128, v132, s[98:99]
  v_lshlrev_b32 v228, 16, v132
  v_and_b32 v229, 0xffff0000, v128
  v_lshlrev_b32 v230, 16, v129
  v_and_b32 v231, 0xffff0000, v129
  v_lshlrev_b32 v232, 16, v130
  v_and_b32 v233, 0xffff0000, v130
  s_add_u32 s3, s100, 630784
  s_add_u32 m0, s44, 110592
  s_nop 0
  buffer_load_dwordx4 v24, s[52:55], s3 offen lds
  v_lshlrev_b32 v234, 16, v131
  v_and_b32 v235, 0xffff0000, v131
  v_lshlrev_b32 v236, 16, v134
  v_and_b32 v237, 0xffff0000, v134
  v_lshlrev_b32 v238, 16, v135
  v_and_b32 v239, 0xffff0000, v135
  v_lshlrev_b32 v240, 16, v136
  v_and_b32 v241, 0xffff0000, v136
  v_lshlrev_b32 v242, 16, v137
  v_and_b32 v243, 0xffff0000, v137
  v_lshlrev_b32 v133, 16, v133
  s_add_u32 s3, s100, 688128
  s_add_u32 m0, s44, 114688
  s_nop 0
  buffer_load_dwordx4 v24, s[52:55], s3 offen lds
  v_cndmask_b32 v243, v243, v133, s[98:99]
  s_add_u32 s3, s100, 745472
  s_add_u32 m0, s44, 118784
  s_nop 0
  buffer_load_dwordx4 v24, s[52:55], s3 offen lds
  s_add_u32 s3, s100, 802816
  s_add_u32 m0, s44, 122880
  s_nop 0
  buffer_load_dwordx4 v24, s[52:55], s3 offen lds
  s_add_u32 m0, s44, 126976
  s_nop 0
  buffer_load_dwordx4 v26, s[52:55], 0 offen lds
  s_waitcnt lgkmcnt(0)
  s_barrier
  ds_read_b128 v[204:207], v11 offset:0
  ds_read_b128 v[208:211], v11 offset:1024
  ds_read_b128 v[212:215], v11 offset:2048
  ds_read_b128 v[216:219], v11 offset:3072
  ds_read_b128 v[220:223], v11 offset:4096
  ds_read_b128 v[224:227], v11 offset:5120
  s_waitcnt lgkmcnt(4)
  v_pk_add_f32 v[196:197], v[196:197], v[204:205]
  v_pk_add_f32 v[198:199], v[198:199], v[206:207]
  v_pk_add_f32 v[200:201], v[200:201], v[208:209]
  v_pk_add_f32 v[202:203], v[202:203], v[210:211]
  s_waitcnt lgkmcnt(2)
  v_pk_add_f32 v[196:197], v[196:197], v[212:213]
  v_pk_add_f32 v[198:199], v[198:199], v[214:215]
  v_pk_add_f32 v[200:201], v[200:201], v[216:217]
  v_pk_add_f32 v[202:203], v[202:203], v[218:219]
  s_waitcnt lgkmcnt(0)
  v_pk_add_f32 v[196:197], v[196:197], v[220:221]
  v_pk_add_f32 v[198:199], v[198:199], v[222:223]
  v_pk_add_f32 v[200:201], v[200:201], v[224:225]
  v_pk_add_f32 v[202:203], v[202:203], v[226:227]
  v_pk_add_f32 v[228:229], v[228:229], v[196:197]
  v_pk_add_f32 v[230:231], v[230:231], v[198:199]
  v_pk_add_f32 v[232:233], v[232:233], v[200:201]
  v_pk_add_f32 v[234:235], v[234:235], v[202:203]
  v_cndmask_b32 v196, v196, 0, s[98:99]
  v_add_f32 v236, v236, v203
  v_add_f32 v237, v237, v202
  v_add_f32 v238, v238, v201
  v_add_f32 v239, v239, v200
  v_add_f32 v240, v240, v199
  v_add_f32 v241, v241, v198
  v_add_f32 v242, v242, v197
  v_add_f32 v243, v243, v196
  v_cvt_pk_bf16_f32 v12, v228, v229
  v_cvt_pk_bf16_f32 v13, v230, v231
  v_cvt_pk_bf16_f32 v14, v232, v233
  v_cvt_pk_bf16_f32 v15, v234, v235
  s_mov_b32 s62, 3145728
  buffer_store_dwordx4 v[12:15], v138, s[24:27], s62 offen sc1
  v_cvt_pk_bf16_f32 v16, v236, v237
  v_cvt_pk_bf16_f32 v17, v238, v239
  v_cvt_pk_bf16_f32 v18, v240, v241
  v_cvt_pk_bf16_f32 v19, v242, v243
  buffer_store_dwordx4 v[16:19], v139, s[24:27], s62 offen sc1
  v_pk_add_f32 v[204:205], v[228:229], v[230:231]
  v_pk_mul_f32 v[206:207], v[228:229], v[228:229]
  v_pk_add_f32 v[204:205], v[204:205], v[232:233]
  v_pk_fma_f32 v[206:207], v[230:231], v[230:231], v[206:207]
  v_pk_add_f32 v[204:205], v[204:205], v[234:235]
  v_pk_fma_f32 v[206:207], v[232:233], v[232:233], v[206:207]
  v_add_f32 v204, v204, v205
  v_pk_fma_f32 v[206:207], v[234:235], v[234:235], v[206:207]
  v_add_f32 v205, v206, v207
  v_pk_add_f32 v[208:209], v[236:237], v[238:239]
  v_pk_mul_f32 v[210:211], v[236:237], v[236:237]
  v_pk_add_f32 v[208:209], v[208:209], v[240:241]
  v_pk_fma_f32 v[210:211], v[238:239], v[238:239], v[210:211]
  v_pk_add_f32 v[208:209], v[208:209], v[242:243]
  v_pk_fma_f32 v[210:211], v[240:241], v[240:241], v[210:211]
  v_add_f32 v208, v208, v209
  v_pk_fma_f32 v[210:211], v[242:243], v[242:243], v[210:211]
  v_add_f32 v209, v210, v211
  v_permlane32_swap_b32 v204, v208
  s_nop 0
  v_permlane32_swap_b32 v205, v209
  v_pk_add_f32 v[204:205], v[204:205], v[208:209]
  s_mov_b32 s62, 524288
  buffer_store_dwordx2 v[204:205], v140, s[24:27], s62 offen sc1
  s_lshl_b32 s62, s40, 9
  s_add_u32 s62, s62, 0
  buffer_load_dwordx4 v[208:211], v43, s[24:27], s62 offen sc1
  s_lshl_b32 s62, s41, 9
  s_add_u32 s62, s62, 0
  buffer_load_dwordx4 v[212:215], v43, s[24:27], s62 offen sc1
  s_lshl_b32 s62, s42, 9
  s_add_u32 s62, s62, 0
  buffer_load_dwordx4 v[216:219], v43, s[24:27], s62 offen sc1
  s_lshl_b32 s62, s43, 9
  s_add_u32 s62, s62, 0
  buffer_load_dwordx4 v[220:223], v43, s[24:27], s62 offen sc1
  s_lshl_b32 s62, s68, 9
  s_add_u32 s62, s62, 0
  buffer_load_dwordx4 v[224:227], v43, s[24:27], s62 offen sc1
  s_lshl_b32 s62, s69, 9
  s_add_u32 s62, s62, 0
  buffer_load_dwordx4 v[228:231], v43, s[24:27], s62 offen sc1
  s_lshl_b32 s62, s70, 9
  s_add_u32 s62, s62, 0
  buffer_load_dwordx4 v[232:235], v43, s[24:27], s62 offen sc1
  s_waitcnt vmcnt(7)
  s_mov_b64 exec, 1
  v_mov_b32 v16, 131072
  v_mov_b32 v17, s39
  buffer_store_dword v17, v16, s[24:27], s78 offen sc1
  s_mov_b64 exec, -1
  s_barrier
  s_add_u32 m0, s45, 131072
  s_mov_b32 exec_hi, 0xffff
  buffer_load_dwordx4 v28, s[52:55], 0 offen lds
  s_mov_b32 exec_hi, -1
  s_waitcnt vmcnt(2)
  s_mov_b32 s63, 0
CSL_5:
  v_xor_b32 v240, s39, v209
  v_xor_b32 v241, s39, v211
  v_xor_b32 v242, s39, v213
  v_xor_b32 v243, s39, v215
  v_or3_b32 v240, v240, v242, v243
  v_xor_b32 v242, s39, v217
  v_xor_b32 v243, s39, v219
  v_or3_b32 v240, v240, v242, v243
  v_xor_b32 v242, s39, v221
  v_xor_b32 v243, s39, v223
  v_or3_b32 v240, v240, v242, v243
  v_xor_b32 v242, s39, v225
  v_xor_b32 v243, s39, v227
  v_or3_b32 v240, v240, v242, v243
  v_xor_b32 v242, s39, v229
  v_xor_b32 v243, s39, v231
  v_or3_b32 v240, v240, v242, v243
  v_xor_b32 v242, s39, v233
  v_xor_b32 v243, s39, v235
  v_or3_b32 v240, v240, v242, v243
  v_or_b32 v240, v240, v241
  v_cmp_ne_u32 vcc, 0, v240
  s_add_u32 s63, s63, 1
  s_cmp_gt_u32 s63, 400000
  s_cbranch_scc1 CSD_6
  s_cbranch_vccz CSD_6
  s_lshl_b32 s62, s40, 9
  s_add_u32 s62, s62, 0
  buffer_load_dwordx4 v[208:211], v43, s[24:27], s62 offen sc1
  s_lshl_b32 s62, s41, 9
  s_add_u32 s62, s62, 0
  buffer_load_dwordx4 v[212:215], v43, s[24:27], s62 offen sc1
  s_lshl_b32 s62, s42, 9
  s_add_u32 s62, s62, 0
  buffer_load_dwordx4 v[216:219], v43, s[24:27], s62 offen sc1
  s_lshl_b32 s62, s43, 9
  s_add_u32 s62, s62, 0
  buffer_load_dwordx4 v[220:223], v43, s[24:27], s62 offen sc1
  s_lshl_b32 s62, s68, 9
  s_add_u32 s62, s62, 0
  buffer_load_dwordx4 v[224:227], v43, s[24:27], s62 offen sc1
  s_lshl_b32 s62, s69, 9
  s_add_u32 s62, s62, 0
  buffer_load_dwordx4 v[228:231], v43, s[24:27], s62 offen sc1
  s_lshl_b32 s62, s70, 9
  s_add_u32 s62, s62, 0
  buffer_load_dwordx4 v[232:235], v43, s[24:27], s62 offen sc1
  s_waitcnt vmcnt(0)
  s_branch CSL_5
CSD_6:
  v_mov_b32 v60, 0
  v_mov_b32 v61, 0
  v_mov_b32 v238, 0
  v_mov_b32 v239, 0
  v_add_u32 v44, 0x10000, v40
  v_add_f32 v208, v208, v210
  v_mov_b32 v209, v208
  v_add_f32 v212, v212, v214
  v_mov_b32 v213, v212
  s_add_u32 s3, s96, 57344
  s_add_u32 m0, s45, 135168
  s_mov_b32 exec_hi, 0xffff
  buffer_load_dwordx4 v27, s[52:55], s3 offen lds
  s_mov_b32 exec_hi, -1
  v_add_f32 v216, v216, v218
  v_mov_b32 v217, v216
  v_add_f32 v220, v220, v222
  v_mov_b32 v221, v220
  v_add_f32 v224, v224, v226
  v_mov_b32 v225, v224
  v_add_f32 v228, v228, v230
  v_mov_b32 v229, v228
  v_add_f32 v232, v232, v234
  s_add_u32 s3, s96, 114688
  s_add_u32 m0, s45, 139264
  s_mov_b32 exec_hi, 0xffff
  buffer_load_dwordx4 v27, s[52:55], s3 offen lds
  s_mov_b32 exec_hi, -1
  v_mov_b32 v233, v232
  v_permlane32_swap_b32 v208, v209
  v_permlane32_swap_b32 v212, v213
  v_permlane32_swap_b32 v216, v217
  v_permlane32_swap_b32 v220, v221
  v_permlane32_swap_b32 v224, v225
  v_permlane32_swap_b32 v228, v229
  v_permlane32_swap_b32 v232, v233
  v_add_f32 v208, v208, v209
  s_add_u32 s3, s96, 172032
  s_add_u32 m0, s45, 143360
  s_mov_b32 exec_hi, 0xffff
  buffer_load_dwordx4 v27, s[52:55], s3 offen lds
  s_mov_b32 exec_hi, -1
  v_and_b32 v209, 0xffff0000, v208
  v_sub_f32 v208, v208, v209
  v_lshrrev_b32 v47, 16, v209
  v_cvt_pk_bf16_f32 v46, v209, v208
  v_add_f32 v212, v212, v213
  v_and_b32 v213, 0xffff0000, v212
  v_sub_f32 v212, v212, v213
  v_lshrrev_b32 v49, 16, v213
  v_cvt_pk_bf16_f32 v48, v213, v212
  s_add_u32 s3, s96, 229376
  s_add_u32 m0, s45, 147456
  s_mov_b32 exec_hi, 0xffff
  buffer_load_dwordx4 v27, s[52:55], s3 offen lds
  s_mov_b32 exec_hi, -1
  v_add_f32 v216, v216, v217
  v_and_b32 v217, 0xffff0000, v216
  v_sub_f32 v216, v216, v217
  v_lshrrev_b32 v51, 16, v217
  v_cvt_pk_bf16_f32 v50, v217, v216
  v_add_f32 v220, v220, v221
  v_and_b32 v221, 0xffff0000, v220
  v_sub_f32 v220, v220, v221
  v_lshrrev_b32 v53, 16, v221
  s_add_u32 s3, s96, 286720
  s_add_u32 m0, s45, 151552
  s_mov_b32 exec_hi, 0xffff
  buffer_load_dwordx4 v27, s[52:55], s3 offen lds
  s_mov_b32 exec_hi, -1
  v_cvt_pk_bf16_f32 v52, v221, v220
  v_add_f32 v224, v224, v225
  v_and_b32 v225, 0xffff0000, v224
  v_sub_f32 v224, v224, v225
  v_lshrrev_b32 v55, 16, v225
  v_cvt_pk_bf16_f32 v54, v225, v224
  v_add_f32 v228, v228, v229
  v_and_b32 v229, 0xffff0000, v228
  v_sub_f32 v228, v228, v229
  s_add_u32 s3, s96, 344064
  s_add_u32 m0, s45, 155648
  s_mov_b32 exec_hi, 0xffff
  buffer_load_dwordx4 v27, s[52:55], s3 offen lds
  s_mov_b32 exec_hi, -1
  v_lshrrev_b32 v57, 16, v229
  v_cvt_pk_bf16_f32 v56, v229, v228
  v_add_f32 v232, v232, v233
  v_and_b32 v233, 0xffff0000, v232
  v_sub_f32 v232, v232, v233
  v_lshrrev_b32 v59, 16, v233
  v_cvt_pk_bf16_f32 v58, v233, v232
  s_lshl_b32 s46, s61, 15
  s_add_u32 s46, s46, 524288
  s_add_u32 s3, s96, 401408
  s_add_u32 m0, s45, 159744
  s_mov_b32 exec_hi, 0xffff
  buffer_load_dwordx4 v27, s[52:55], s3 offen lds
  s_mov_b32 exec_hi, -1
  s_lshl_b32 s50, s61, 17
  s_add_u32 s50, s50, 3145728
  s_bfe_u32 s62, s38, 0x30001
  s_mul_i32 s62, s62, 112
  s_mul_i32 s63, s36, 28
  s_add_u32 s62, s62, s63
  s_lshl_b32 s91, s62, 11
  s_add_u32 s91, s91, 13631488
  s_add_u32 s83, s91, 32768
  s_lshl_b32 s63, s62, 6
  s_add_u32 s63, s63, 13107200
  v_min_u32 v255, 27, v1
  v_lshl_add_u32 v255, v255, 6, s63
  s_mov_b32 s62, 0
POLL_7:
  buffer_load_dword v8, v255, s[24:27], 0 offen sc1
  s_add_u32 s62, s62, 1
  s_waitcnt vmcnt(0)
  v_cmp_ne_u32 vcc, s39, v8
  s_cmp_gt_u32 s62, 400000
  s_cbranch_scc1 PDONE_8
  s_cbranch_vccz PDONE_8
  s_branch POLL_7
PDONE_8:
  ds_read_b64_tr_b16 v[176:177], v35 offset:0
  ds_read_b64_tr_b16 v[178:179], v35 offset:512
  ds_read_b64_tr_b16 v[180:181], v36 offset:0
  ds_read_b64_tr_b16 v[182:183], v36 offset:512
  ds_read_b64_tr_b16 v[184:185], v37 offset:0
  ds_read_b64_tr_b16 v[186:187], v37 offset:512
  ds_read_b64_tr_b16 v[188:189], v38 offset:0
  ds_read_b64_tr_b16 v[190:191], v38 offset:512
  ds_read_b64_tr_b16 v[192:193], v35 offset:4096
  ds_read_b64_tr_b16 v[194:195], v35 offset:4608
  s_lshl_b32 s63, s37, 2
  s_add_u32 s63, s63, s36
  s_lshl_b32 s63, s63, 11
  s_add_u32 s63, s63, 131072
  v_lshlrev_b32 v12, 6, v4
  s_mov_b32 s62, 0
POLL_9:
  buffer_load_dword v8, v12, s[24:27], s63 offen sc1
  s_add_u32 s62, s62, 1
  s_waitcnt vmcnt(0)
  v_cmp_ne_u32 vcc, s39, v8
  s_cmp_gt_u32 s62, 400000
  s_cbranch_scc1 PDONE_10
  s_cbranch_vccz PDONE_10
  s_branch POLL_9
PDONE_10:
  buffer_load_dwordx4 a[128:131], v41, s[24:27], s50 offen offset:0 sc1
  buffer_load_dwordx4 a[132:135], v41, s[24:27], s50 offen offset:1024 sc1
  buffer_load_dwordx4 a[136:139], v41, s[24:27], s50 offen offset:2048 sc1
  buffer_load_dwordx4 a[140:143], v41, s[24:27], s50 offen offset:3072 sc1
  s_add_u32 s50, s50, 4096
  buffer_load_dwordx4 a[144:147], v41, s[24:27], s50 offen offset:0 sc1
  buffer_load_dwordx4 a[148:151], v41, s[24:27], s50 offen offset:1024 sc1
  buffer_load_dwordx4 a[152:155], v41, s[24:27], s50 offen offset:2048 sc1
  buffer_load_dwordx4 a[156:159], v41, s[24:27], s50 offen offset:3072 sc1
  s_add_u32 s50, s50, 4096
  buffer_load_dwordx4 a[160:163], v41, s[24:27], s50 offen offset:0 sc1
  buffer_load_dwordx4 a[164:167], v41, s[24:27], s50 offen offset:1024 sc1
  s_waitcnt vmcnt(9)
  s_waitcnt lgkmcnt(6)
  v_mfma_f32_32x32x16_bf16 v[64:79], v[176:179], a[128:131], 0
  ds_read_b64_tr_b16 v[196:197], v36 offset:4096
  ds_read_b64_tr_b16 v[198:199], v36 offset:4608
  buffer_load_dwordx4 a[168:171], v41, s[24:27], s50 offen offset:2048 sc1
  v_mfma_f32_32x32x16_bf16 v[80:95], v[180:183], a[128:131], 0
  ds_read_b64_tr_b16 v[200:201], v37 offset:4096
  ds_read_b64_tr_b16 v[202:203], v37 offset:4608
  buffer_load_dwordx4 a[172:175], v41, s[24:27], s50 offen offset:3072 sc1
  s_waitcnt lgkmcnt(6)
  v_mfma_f32_32x32x16_bf16 v[96:111], v[184:187], a[128:131], 0
  ds_read_b64_tr_b16 v[204:205], v38 offset:4096
  ds_read_b64_tr_b16 v[206:207], v38 offset:4608
  v_mfma_f32_32x32x16_bf16 v[112:127], v[188:191], a[128:131], 0
  ds_read_b64_tr_b16 v[176:177], v35 offset:8192
  ds_read_b64_tr_b16 v[178:179], v35 offset:8704
  s_add_u32 s50, s50, 4096
  buffer_load_dwordx4 a[176:179], v41, s[24:27], s50 offen offset:0 sc1
  s_waitcnt vmcnt(11)
  s_waitcnt lgkmcnt(6)
  v_mfma_f32_32x32x16_bf16 v[64:79], v[192:195], a[132:135], v[64:79]
  ds_read_b64_tr_b16 v[180:181], v36 offset:8192
  ds_read_b64_tr_b16 v[182:183], v36 offset:8704
  v_mfma_f32_32x32x16_bf16 v[80:95], v[196:199], a[132:135], v[80:95]
  ds_read_b64_tr_b16 v[184:185], v37 offset:8192
  ds_read_b64_tr_b16 v[186:187], v37 offset:8704
  buffer_load_dwordx4 a[180:183], v41, s[24:27], s50 offen offset:1024 sc1
  s_waitcnt lgkmcnt(6)
  v_mfma_f32_32x32x16_bf16 v[96:111], v[200:203], a[132:135], v[96:111]
  ds_read_b64_tr_b16 v[188:189], v38 offset:8192
  ds_read_b64_tr_b16 v[190:191], v38 offset:8704
  v_mfma_f32_32x32x16_bf16 v[112:127], v[204:207], a[132:135], v[112:127]
  ds_read_b64_tr_b16 v[192:193], v35 offset:12288
  ds_read_b64_tr_b16 v[194:195], v35 offset:12800
  buffer_load_dwordx4 a[184:187], v41, s[24:27], s50 offen offset:2048 sc1
  s_waitcnt vmcnt(12)
  s_waitcnt lgkmcnt(6)
  v_mfma_f32_32x32x16_bf16 v[64:79], v[176:179], a[136:139], v[64:79]
  ds_read_b64_tr_b16 v[196:197], v36 offset:12288
  ds_read_b64_tr_b16 v[198:199], v36 offset:12800
  v_mfma_f32_32x32x16_bf16 v[80:95], v[180:183], a[136:139], v[80:95]
  ds_read_b64_tr_b16 v[200:201], v37 offset:12288
  ds_read_b64_tr_b16 v[202:203], v37 offset:12800
  buffer_load_dwordx4 a[188:191], v41, s[24:27], s50 offen offset:3072 sc1
  s_waitcnt lgkmcnt(6)
  v_mfma_f32_32x32x16_bf16 v[96:111], v[184:187], a[136:139], v[96:111]
  ds_read_b64_tr_b16 v[204:205], v38 offset:12288
  ds_read_b64_tr_b16 v[206:207], v38 offset:12800
  v_mfma_f32_32x32x16_bf16 v[112:127], v[188:191], a[136:139], v[112:127]
  ds_read_b64_tr_b16 v[176:177], v35 offset:16384
  ds_read_b64_tr_b16 v[178:179], v35 offset:16896
  buffer_load_dwordx4 v[128:131], v42, s[24:27], s46 offen offset:0 sc1
  s_waitcnt vmcnt(13)
  s_waitcnt lgkmcnt(6)
  v_mfma_f32_32x32x16_bf16 v[64:79], v[192:195], a[140:143], v[64:79]
  ds_read_b64_tr_b16 v[180:181], v36 offset:16384
  ds_read_b64_tr_b16 v[182:183], v36 offset:16896
  v_mfma_f32_32x32x16_bf16 v[80:95], v[196:199], a[140:143], v[80:95]
  ds_read_b64_tr_b16 v[184:185], v37 offset:16384
  ds_read_b64_tr_b16 v[186:187], v37 offset:16896
  buffer_load_dwordx4 v[132:135], v42, s[24:27], s46 offen offset:512 sc1
  s_waitcnt lgkmcnt(6)
  v_mfma_f32_32x32x16_bf16 v[96:111], v[200:203], a[140:143], v[96:111]
  ds_read_b64_tr_b16 v[188:189], v38 offset:16384
  ds_read_b64_tr_b16 v[190:191], v38 offset:16896
  v_mfma_f32_32x32x16_bf16 v[112:127], v[204:207], a[140:143], v[112:127]
  ds_read_b64_tr_b16 v[192:193], v35 offset:20480
  ds_read_b64_tr_b16 v[194:195], v35 offset:20992
  buffer_load_dwordx4 v[136:139], v42, s[24:27], s46 offen offset:1024 sc1
  s_waitcnt vmcnt(14)
  s_waitcnt lgkmcnt(6)
  v_mfma_f32_32x32x16_bf16 v[64:79], v[176:179], a[144:147], v[64:79]
  ds_read_b64_tr_b16 v[196:197], v36 offset:20480
  ds_read_b64_tr_b16 v[198:199], v36 offset:20992
  v_mfma_f32_32x32x16_bf16 v[80:95], v[180:183], a[144:147], v[80:95]
  ds_read_b64_tr_b16 v[200:201], v37 offset:20480
  ds_read_b64_tr_b16 v[202:203], v37 offset:20992
  buffer_load_dwordx4 v[140:143], v42, s[24:27], s46 offen offset:1536 sc1
  s_waitcnt lgkmcnt(6)
  v_mfma_f32_32x32x16_bf16 v[96:111], v[184:187], a[144:147], v[96:111]
  ds_read_b64_tr_b16 v[204:205], v38 offset:20480
  ds_read_b64_tr_b16 v[206:207], v38 offset:20992
  v_mfma_f32_32x32x16_bf16 v[112:127], v[188:191], a[144:147], v[112:127]
  ds_read_b64_tr_b16 v[176:177], v35 offset:24576
  ds_read_b64_tr_b16 v[178:179], v35 offset:25088
  buffer_load_dwordx4 v[144:147], v42, s[24:27], s46 offen offset:2048 sc1
  s_waitcnt vmcnt(15)
  s_waitcnt lgkmcnt(6)
  v_mfma_f32_32x32x16_bf16 v[64:79], v[192:195], a[148:151], v[64:79]
  ds_read_b64_tr_b16 v[180:181], v36 offset:24576
  ds_read_b64_tr_b16 v[182:183], v36 offset:25088
  v_mfma_f32_32x32x16_bf16 v[80:95], v[196:199], a[148:151], v[80:95]
  ds_read_b64_tr_b16 v[184:185], v37 offset:24576
  ds_read_b64_tr_b16 v[186:187], v37 offset:25088
  buffer_load_dwordx4 v[148:151], v42, s[24:27], s46 offen offset:2560 sc1
  s_waitcnt lgkmcnt(6)
  v_mfma_f32_32x32x16_bf16 v[96:111], v[200:203], a[148:151], v[96:111]
  ds_read_b64_tr_b16 v[188:189], v38 offset:24576
  ds_read_b64_tr_b16 v[190:191], v38 offset:25088
  v_mfma_f32_32x32x16_bf16 v[112:127], v[204:207], a[148:151], v[112:127]
  ds_read_b64_tr_b16 v[192:193], v35 offset:28672
  ds_read_b64_tr_b16 v[194:195], v35 offset:29184
  buffer_load_dwordx4 v[152:155], v42, s[24:27], s46 offen offset:3072 sc1
  s_waitcnt vmcnt(16)
  s_waitcnt lgkmcnt(6)
  v_mfma_f32_32x32x16_bf16 v[64:79], v[176:179], a[152:155], v[64:79]
  ds_read_b64_tr_b16 v[196:197], v36 offset:28672
  ds_read_b64_tr_b16 v[198:199], v36 offset:29184
  v_mfma_f32_32x32x16_bf16 v[80:95], v[180:183], a[152:155], v[80:95]
  ds_read_b64_tr_b16 v[200:201], v37 offset:28672
  ds_read_b64_tr_b16 v[202:203], v37 offset:29184
  buffer_load_dwordx4 v[156:159], v42, s[24:27], s46 offen offset:3584 sc1
  s_waitcnt lgkmcnt(6)
  v_mfma_f32_32x32x16_bf16 v[96:111], v[184:187], a[152:155], v[96:111]
  ds_read_b64_tr_b16 v[204:205], v38 offset:28672
  ds_read_b64_tr_b16 v[206:207], v38 offset:29184
  v_mfma_f32_32x32x16_bf16 v[112:127], v[188:191], a[152:155], v[112:127]
  ds_read_b64_tr_b16 v[176:177], v35 offset:32768
  ds_read_b64_tr_b16 v[178:179], v35 offset:33280
  s_add_u32 s50, s50, 4096
  buffer_load_dwordx4 a[192:195], v41, s[24:27], s50 offen offset:0 sc1
  s_waitcnt vmcnt(17)
  s_waitcnt lgkmcnt(6)
  v_mfma_f32_32x32x16_bf16 v[64:79], v[192:195], a[156:159], v[64:79]
  ds_read_b64_tr_b16 v[180:181], v36 offset:32768
  ds_read_b64_tr_b16 v[182:183], v36 offset:33280
  v_mfma_f32_32x32x16_bf16 v[80:95], v[196:199], a[156:159], v[80:95]
  ds_read_b64_tr_b16 v[184:185], v37 offset:32768
  ds_read_b64_tr_b16 v[186:187], v37 offset:33280
  buffer_load_dwordx4 a[196:199], v41, s[24:27], s50 offen offset:1024 sc1
  s_waitcnt lgkmcnt(6)
  v_mfma_f32_32x32x16_bf16 v[96:111], v[200:203], a[156:159], v[96:111]
  ds_read_b64_tr_b16 v[188:189], v38 offset:32768
  ds_read_b64_tr_b16 v[190:191], v38 offset:33280
  v_mfma_f32_32x32x16_bf16 v[112:127], v[204:207], a[156:159], v[112:127]
  ds_read_b64_tr_b16 v[192:193], v35 offset:36864
  ds_read_b64_tr_b16 v[194:195], v35 offset:37376
  buffer_load_dwordx4 a[200:203], v41, s[24:27], s50 offen offset:2048 sc1
  s_waitcnt vmcnt(18)
  s_waitcnt lgkmcnt(6)
  v_mfma_f32_32x32x16_bf16 v[64:79], v[176:179], a[160:163], v[64:79]
  ds_read_b64_tr_b16 v[196:197], v36 offset:36864
  ds_read_b64_tr_b16 v[198:199], v36 offset:37376
  v_mfma_f32_32x32x16_bf16 v[80:95], v[180:183], a[160:163], v[80:95]
  ds_read_b64_tr_b16 v[200:201], v37 offset:36864
  ds_read_b64_tr_b16 v[202:203], v37 offset:37376
  buffer_load_dwordx4 a[204:207], v41, s[24:27], s50 offen offset:3072 sc1
  s_waitcnt lgkmcnt(6)
  v_mfma_f32_32x32x16_bf16 v[96:111], v[184:187], a[160:163], v[96:111]
  ds_read_b64_tr_b16 v[204:205], v38 offset:36864
  ds_read_b64_tr_b16 v[206:207], v38 offset:37376
  v_mfma_f32_32x32x16_bf16 v[112:127], v[188:191], a[160:163], v[112:127]
  ds_read_b64_tr_b16 v[176:177], v35 offset:40960
  ds_read_b64_tr_b16 v[178:179], v35 offset:41472
  s_add_u32 s50, s50, 4096
  buffer_load_dwordx4 a[208:211], v41, s[24:27], s50 offen offset:0 sc1
  s_waitcnt vmcnt(19)
  s_waitcnt lgkmcnt(6)
  v_mfma_f32_32x32x16_bf16 v[64:79], v[192:195], a[164:167], v[64:79]
  ds_read_b64_tr_b16 v[180:181], v36 offset:40960
  ds_read_b64_tr_b16 v[182:183], v36 offset:41472
  v_mfma_f32_32x32x16_bf16 v[80:95], v[196:199], a[164:167], v[80:95]
  ds_read_b64_tr_b16 v[184:185], v37 offset:40960
  ds_read_b64_tr_b16 v[186:187], v37 offset:41472
  buffer_load_dwordx4 a[212:215], v41, s[24:27], s50 offen offset:1024 sc1
  s_waitcnt lgkmcnt(6)
  v_mfma_f32_32x32x16_bf16 v[96:111], v[200:203], a[164:167], v[96:111]
  ds_read_b64_tr_b16 v[188:189], v38 offset:40960
  ds_read_b64_tr_b16 v[190:191], v38 offset:41472
  v_mfma_f32_32x32x16_bf16 v[112:127], v[204:207], a[164:167], v[112:127]
  ds_read_b64_tr_b16 v[192:193], v35 offset:45056
  ds_read_b64_tr_b16 v[194:195], v35 offset:45568
  buffer_load_dwordx4 a[216:219], v41, s[24:27], s50 offen offset:2048 sc1
  s_waitcnt vmcnt(20)
  s_waitcnt lgkmcnt(6)
  v_mfma_f32_32x32x16_bf16 v[64:79], v[176:179], a[168:171], v[64:79]
  ds_read_b64_tr_b16 v[196:197], v36 offset:45056
  ds_read_b64_tr_b16 v[198:199], v36 offset:45568
  v_mfma_f32_32x32x16_bf16 v[80:95], v[180:183], a[168:171], v[80:95]
  ds_read_b64_tr_b16 v[200:201], v37 offset:45056
  ds_read_b64_tr_b16 v[202:203], v37 offset:45568
  buffer_load_dwordx4 a[220:223], v41, s[24:27], s50 offen offset:3072 sc1
  s_waitcnt lgkmcnt(6)
  v_mfma_f32_32x32x16_bf16 v[96:111], v[184:187], a[168:171], v[96:111]
  ds_read_b64_tr_b16 v[204:205], v38 offset:45056
  ds_read_b64_tr_b16 v[206:207], v38 offset:45568
  v_mfma_f32_32x32x16_bf16 v[112:127], v[188:191], a[168:171], v[112:127]
  ds_read_b64_tr_b16 v[176:177], v35 offset:49152
  ds_read_b64_tr_b16 v[178:179], v35 offset:49664
  s_add_u32 s50, s50, 4096
  buffer_load_dwordx4 a[224:227], v41, s[24:27], s50 offen offset:0 sc1
  s_waitcnt vmcnt(21)
  s_waitcnt lgkmcnt(6)
  v_mfma_f32_32x32x16_bf16 v[64:79], v[192:195], a[172:175], v[64:79]
  ds_read_b64_tr_b16 v[180:181], v36 offset:49152
  ds_read_b64_tr_b16 v[182:183], v36 offset:49664
  v_mfma_f32_32x32x16_bf16 v[80:95], v[196:199], a[172:175], v[80:95]
  ds_read_b64_tr_b16 v[184:185], v37 offset:49152
  ds_read_b64_tr_b16 v[186:187], v37 offset:49664
  buffer_load_dwordx4 a[228:231], v41, s[24:27], s50 offen offset:1024 sc1
  s_waitcnt lgkmcnt(6)
  v_mfma_f32_32x32x16_bf16 v[96:111], v[200:203], a[172:175], v[96:111]
  ds_read_b64_tr_b16 v[188:189], v38 offset:49152
  ds_read_b64_tr_b16 v[190:191], v38 offset:49664
  v_mfma_f32_32x32x16_bf16 v[112:127], v[204:207], a[172:175], v[112:127]
  ds_read_b64_tr_b16 v[192:193], v35 offset:53248
  ds_read_b64_tr_b16 v[194:195], v35 offset:53760
  buffer_load_dwordx4 a[232:235], v41, s[24:27], s50 offen offset:2048 sc1
  s_waitcnt vmcnt(22)
  s_waitcnt lgkmcnt(6)
  v_mfma_f32_32x32x16_bf16 v[64:79], v[176:179], a[176:179], v[64:79]
  ds_read_b64_tr_b16 v[196:197], v36 offset:53248
  ds_read_b64_tr_b16 v[198:199], v36 offset:53760
  v_mfma_f32_32x32x16_bf16 v[80:95], v[180:183], a[176:179], v[80:95]
  ds_read_b64_tr_b16 v[200:201], v37 offset:53248
  ds_read_b64_tr_b16 v[202:203], v37 offset:53760
  buffer_load_dwordx4 a[236:239], v41, s[24:27], s50 offen offset:3072 sc1
  s_waitcnt lgkmcnt(6)
  v_mfma_f32_32x32x16_bf16 v[96:111], v[184:187], a[176:179], v[96:111]
  ds_read_b64_tr_b16 v[204:205], v38 offset:53248
  ds_read_b64_tr_b16 v[206:207], v38 offset:53760
  s_waitcnt vmcnt(12)
  v_mfma_f32_32x32x16_bf16 v[112:127], v[188:191], a[176:179], v[112:127]
  ds_read_b64_tr_b16 v[176:177], v35 offset:57344
  ds_read_b64_tr_b16 v[178:179], v35 offset:57856
  v_add_f32 v128, v128, v130
  v_add_f32 v132, v132, v134
  v_add_f32 v136, v136, v138
  s_add_u32 s50, s50, 4096
  buffer_load_dwordx4 a[240:243], v41, s[24:27], s50 offen offset:0 sc1
  s_waitcnt vmcnt(23)
  s_waitcnt lgkmcnt(6)
  v_mfma_f32_32x32x16_bf16 v[64:79], v[192:195], a[180:183], v[64:79]
  ds_read_b64_tr_b16 v[180:181], v36 offset:57344
  ds_read_b64_tr_b16 v[182:183], v36 offset:57856
  v_add_f32 v140, v140, v142
  v_mfma_f32_32x32x16_bf16 v[80:95], v[196:199], a[180:183], v[80:95]
  ds_read_b64_tr_b16 v[184:185], v37 offset:57344
  ds_read_b64_tr_b16 v[186:187], v37 offset:57856
  v_add_f32 v144, v144, v146
  v_add_f32 v148, v148, v150
  v_add_f32 v152, v152, v154
  buffer_load_dwordx4 a[244:247], v41, s[24:27], s50 offen offset:1024 sc1
  s_waitcnt lgkmcnt(6)
  v_mfma_f32_32x32x16_bf16 v[96:111], v[200:203], a[180:183], v[96:111]
  ds_read_b64_tr_b16 v[188:189], v38 offset:57344
  ds_read_b64_tr_b16 v[190:191], v38 offset:57856
  v_add_f32 v156, v156, v158
  v_mfma_f32_32x32x16_bf16 v[112:127], v[204:207], a[180:183], v[112:127]
  ds_read_b64_tr_b16 v[192:193], v35 offset:61440
  ds_read_b64_tr_b16 v[194:195], v35 offset:61952
  v_add_f32 v128, v128, v144
  v_add_f32 v132, v132, v148
  v_add_f32 v136, v136, v152
  buffer_load_dwordx4 a[248:251], v41, s[24:27], s50 offen offset:2048 sc1
  s_waitcnt vmcnt(24)
  s_waitcnt lgkmcnt(6)
  v_mfma_f32_32x32x16_bf16 v[64:79], v[176:179], a[184:187], v[64:79]
  ds_read_b64_tr_b16 v[196:197], v36 offset:61440
  ds_read_b64_tr_b16 v[198:199], v36 offset:61952
  v_add_f32 v140, v140, v156
  v_mfma_f32_32x32x16_bf16 v[80:95], v[180:183], a[184:187], v[80:95]
  ds_read_b64_tr_b16 v[200:201], v37 offset:61440
  ds_read_b64_tr_b16 v[202:203], v37 offset:61952
  v_add_f32 v128, v128, v136
  v_add_f32 v132, v132, v140
  v_add_f32 v128, v128, v132
  buffer_load_dwordx4 a[252:255], v41, s[24:27], s50 offen offset:3072 sc1
  s_waitcnt lgkmcnt(6)
  v_mfma_f32_32x32x16_bf16 v[96:111], v[184:187], a[184:187], v[96:111]
  ds_read_b64_tr_b16 v[204:205], v38 offset:61440
  ds_read_b64_tr_b16 v[206:207], v38 offset:61952
  v_add_f32 v129, v129, v131
  v_mfma_f32_32x32x16_bf16 v[112:127], v[188:191], a[184:187], v[112:127]
  v_add_u32 v35, 0x10000, v35
  ds_read_b64_tr_b16 v[176:177], v35 offset:0
  ds_read_b64_tr_b16 v[178:179], v35 offset:512
  v_add_f32 v133, v133, v135
  v_add_f32 v137, v137, v139
  v_add_f32 v141, v141, v143
  s_barrier
  s_add_u32 s3, s96, 458752
  s_add_u32 m0, s45, 0
  s_mov_b32 exec_hi, 0xffff
  buffer_load_dwordx4 v27, s[52:55], s3 offen lds
  s_mov_b32 exec_hi, -1
  s_waitcnt vmcnt(25)
  s_waitcnt lgkmcnt(6)
  v_mfma_f32_32x32x16_bf16 v[64:79], v[192:195], a[188:191], v[64:79]
  v_add_u32 v36, 0x10000, v36
  ds_read_b64_tr_b16 v[180:181], v36 offset:0
  ds_read_b64_tr_b16 v[182:183], v36 offset:512
  v_mfma_f32_32x32x16_bf16 v[80:95], v[196:199], a[188:191], v[80:95]
  v_add_u32 v37, 0x10000, v37
  ds_read_b64_tr_b16 v[184:185], v37 offset:0
  ds_read_b64_tr_b16 v[186:187], v37 offset:512
  v_add_f32 v145, v145, v147
  v_add_f32 v149, v149, v151
  v_add_f32 v153, v153, v155
  s_waitcnt lgkmcnt(6)
  v_mfma_f32_32x32x16_bf16 v[96:111], v[200:203], a[188:191], v[96:111]
  v_add_u32 v38, 0x10000, v38
  ds_read_b64_tr_b16 v[188:189], v38 offset:0
  ds_read_b64_tr_b16 v[190:191], v38 offset:512
  v_add_f32 v157, v157, v159
  v_add_f32 v129, v129, v145
  v_add_f32 v133, v133, v149
  buffer_load_dwordx4 a[0:3], v31, s[24:27], s91 offen offset:0 sc1
  v_mfma_f32_32x32x16_bf16 v[112:127], v[204:207], a[188:191], v[112:127]
  ds_read_b64_tr_b16 v[192:193], v35 offset:4096
  ds_read_b64_tr_b16 v[194:195], v35 offset:4608
  v_add_f32 v137, v137, v153
  s_waitcnt vmcnt(17)
  s_waitcnt lgkmcnt(6)
  v_mfma_f32_32x32x16_bf16 v[64:79], v[176:179], a[192:195], v[64:79]
  ds_read_b64_tr_b16 v[196:197], v36 offset:4096
  ds_read_b64_tr_b16 v[198:199], v36 offset:4608
  v_add_f32 v141, v141, v157
  v_add_f32 v129, v129, v137
  v_add_f32 v133, v133, v141
  s_add_u32 s3, s96, 516096
  s_add_u32 m0, s45, 4096
  s_mov_b32 exec_hi, 0xffff
  buffer_load_dwordx4 v27, s[52:55], s3 offen lds
  s_mov_b32 exec_hi, -1
  v_mfma_f32_32x32x16_bf16 v[80:95], v[180:183], a[192:195], v[80:95]
  ds_read_b64_tr_b16 v[200:201], v37 offset:4096
  ds_read_b64_tr_b16 v[202:203], v37 offset:4608
  v_add_f32 v129, v129, v133
  s_waitcnt lgkmcnt(6)
  v_mfma_f32_32x32x16_bf16 v[96:111], v[184:187], a[192:195], v[96:111]
  ds_read_b64_tr_b16 v[204:205], v38 offset:4096
  ds_read_b64_tr_b16 v[206:207], v38 offset:4608
  v_mov_b32 v130, v128
  v_mov_b32 v131, v129
  s_nop 0
  v_permlane32_swap_b32 v128, v130
  v_mfma_f32_32x32x16_bf16 v[112:127], v[188:191], a[192:195], v[112:127]
  ds_read_b64_tr_b16 v[176:177], v35 offset:8192
  ds_read_b64_tr_b16 v[178:179], v35 offset:8704
  v_permlane32_swap_b32 v129, v131
  v_cmp_eq_u32 vcc, 0, v5
  v_add_f32 v128, v128, v130
  buffer_load_dwordx4 a[4:7], v32, s[24:27], s91 offen offset:0 sc1
  s_waitcnt vmcnt(18)
  s_waitcnt lgkmcnt(6)
  v_mfma_f32_32x32x16_bf16 v[64:79], v[192:195], a[196:199], v[64:79]
  ds_read_b64_tr_b16 v[180:181], v36 offset:8192
  ds_read_b64_tr_b16 v[182:183], v36 offset:8704
  v_add_f32 v129, v129, v131
  v_mfma_f32_32x32x16_bf16 v[80:95], v[196:199], a[196:199], v[80:95]
  ds_read_b64_tr_b16 v[184:185], v37 offset:8192
  ds_read_b64_tr_b16 v[186:187], v37 offset:8704
  v_mul_f32 v128, 0x3b000000, v128
  v_mul_f32 v129, 0x3b000000, v129
  v_fma_f32 v129, -v128, v128, v129
  s_add_u32 s3, s96, 573440
  s_add_u32 m0, s45, 8192
  s_mov_b32 exec_hi, 0xffff
  buffer_load_dwordx4 v27, s[52:55], s3 offen lds
  s_mov_b32 exec_hi, -1
  s_waitcnt lgkmcnt(6)
  v_mfma_f32_32x32x16_bf16 v[96:111], v[200:203], a[196:199], v[96:111]
  ds_read_b64_tr_b16 v[188:189], v38 offset:8192
  ds_read_b64_tr_b16 v[190:191], v38 offset:8704
  v_add_f32 v250, 0x3727c5ac, v129
  v_mfma_f32_32x32x16_bf16 v[112:127], v[204:207], a[196:199], v[112:127]
  ds_read_b64_tr_b16 v[192:193], v35 offset:12288
  ds_read_b64_tr_b16 v[194:195], v35 offset:12800
  v_rsq_f32 v130, v250
  v_and_b32 v131, 0xffff0000, v128
  s_waitcnt vmcnt(18)
  s_waitcnt lgkmcnt(6)
  v_mfma_f32_32x32x16_bf16 v[64:79], v[176:179], a[200:203], v[64:79]
  ds_read_b64_tr_b16 v[196:197], v36 offset:12288
  ds_read_b64_tr_b16 v[198:199], v36 offset:12800
  v_sub_f32 v132, v131, v128
  v_mul_f32 v248, 0xc0135761, v130
  v_mul_f32 v249, v130, v130
  buffer_load_dwordx4 a[8:11], v31, s[24:27], s91 offen offset:2048 sc1
  v_mfma_f32_32x32x16_bf16 v[80:95], v[180:183], a[200:203], v[80:95]
  ds_read_b64_tr_b16 v[200:201], v37 offset:12288
  ds_read_b64_tr_b16 v[202:203], v37 offset:12800
  v_cvt_pk_bf16_f32 v236, -v131, -v131
  s_waitcnt lgkmcnt(6)
  v_mfma_f32_32x32x16_bf16 v[96:111], v[184:187], a[200:203], v[96:111]
  ds_read_b64_tr_b16 v[204:205], v38 offset:12288
  ds_read_b64_tr_b16 v[206:207], v38 offset:12800
  v_mul_f32 v249, v249, v130
  v_cvt_pk_bf16_f32 v237, v132, 0
  v_mul_f32 v249, 0xbdd2d3e8, v249
  s_add_u32 s3, s96, 630784
  s_add_u32 m0, s45, 12288
  s_mov_b32 exec_hi, 0xffff
  buffer_load_dwordx4 v27, s[52:55], s3 offen lds
  s_mov_b32 exec_hi, -1
  v_mfma_f32_32x32x16_bf16 v[112:127], v[188:191], a[200:203], v[112:127]
  ds_read_b64_tr_b16 v[176:177], v35 offset:16384
  ds_read_b64_tr_b16 v[178:179], v35 offset:16896
  v_cndmask_b32 v236, 0, v236, vcc
  s_waitcnt vmcnt(19)
  s_waitcnt lgkmcnt(6)
  v_mfma_f32_32x32x16_bf16 v[64:79], v[192:195], a[204:207], v[64:79]
  ds_read_b64_tr_b16 v[180:181], v35 offset:20480
  ds_read_b64_tr_b16 v[182:183], v35 offset:20992
  v_cndmask_b32 v237, 0, v237, vcc
  v_mfma_f32_32x32x16_bf16 v[80:95], v[196:199], a[204:207], v[80:95]
  ds_read_b64_tr_b16 v[184:185], v35 offset:24576
  ds_read_b64_tr_b16 v[186:187], v35 offset:25088
  buffer_load_dwordx4 a[12:15], v32, s[24:27], s91 offen offset:2048 sc1
  s_waitcnt lgkmcnt(6)
  v_mfma_f32_32x32x16_bf16 v[96:111], v[200:203], a[204:207], v[96:111]
  ds_read_b64_tr_b16 v[188:189], v35 offset:28672
  ds_read_b64_tr_b16 v[190:191], v35 offset:29184
  v_mfma_f32_32x32x16_bf16 v[112:127], v[204:207], a[204:207], v[112:127]
  ds_read_b64_tr_b16 v[192:193], v35 offset:32768
  ds_read_b64_tr_b16 v[194:195], v35 offset:33280
  s_add_u32 s3, s96, 688128
  s_add_u32 m0, s45, 16384
  s_mov_b32 exec_hi, 0xffff
  buffer_load_dwordx4 v27, s[52:55], s3 offen lds
  s_mov_b32 exec_hi, -1
  s_waitcnt vmcnt(20)
  s_waitcnt lgkmcnt(6)
  v_mfma_f32_32x32x16_bf16 v[64:79], v[176:179], a[208:211], v[64:79]
  ds_read_b64_tr_b16 v[196:197], v35 offset:36864
  ds_read_b64_tr_b16 v[198:199], v35 offset:37376
  s_waitcnt vmcnt(19)
  v_mfma_f32_32x32x16_bf16 v[64:79], v[180:183], a[212:215], v[64:79]
  ds_read_b64_tr_b16 v[200:201], v35 offset:40960
  ds_read_b64_tr_b16 v[202:203], v35 offset:41472
  s_waitcnt vmcnt(18)
  s_waitcnt lgkmcnt(6)
  v_mfma_f32_32x32x16_bf16 v[64:79], v[184:187], a[216:219], v[64:79]
  ds_read_b64_tr_b16 v[204:205], v35 offset:45056
  ds_read_b64_tr_b16 v[206:207], v35 offset:45568
  s_add_u32 s91, s91, 4096
  buffer_load_dwordx4 a[16:19], v31, s[24:27], s91 offen offset:0 sc1
  s_waitcnt vmcnt(18)
  v_mfma_f32_32x32x16_bf16 v[64:79], v[188:191], a[220:223], v[64:79]
  ds_read_b64_tr_b16 v[176:177], v35 offset:49152
  ds_read_b64_tr_b16 v[178:179], v35 offset:49664
  s_waitcnt vmcnt(17)
  s_waitcnt lgkmcnt(6)
  v_mfma_f32_32x32x16_bf16 v[64:79], v[192:195], a[224:227], v[64:79]
  ds_read_b64_tr_b16 v[180:181], v35 offset:53248
  ds_read_b64_tr_b16 v[182:183], v35 offset:53760
  s_add_u32 s3, s96, 745472
  s_add_u32 m0, s45, 20480
  s_mov_b32 exec_hi, 0xffff
  buffer_load_dwordx4 v27, s[52:55], s3 offen lds
  s_mov_b32 exec_hi, -1
  s_waitcnt vmcnt(17)
  v_mfma_f32_32x32x16_bf16 v[64:79], v[196:199], a[228:231], v[64:79]
  ds_read_b64_tr_b16 v[184:185], v35 offset:57344
  ds_read_b64_tr_b16 v[186:187], v35 offset:57856
  s_waitcnt vmcnt(16)
  s_waitcnt lgkmcnt(6)
  v_mfma_f32_32x32x16_bf16 v[64:79], v[200:203], a[232:235], v[64:79]
  ds_read_b64_tr_b16 v[188:189], v35 offset:61440
  ds_read_b64_tr_b16 v[190:191], v35 offset:61952
  s_waitcnt vmcnt(15)
  v_mfma_f32_32x32x16_bf16 v[64:79], v[204:207], a[236:239], v[64:79]
  ds_read_b64_tr_b16 v[192:193], v36 offset:16384
  ds_read_b64_tr_b16 v[194:195], v36 offset:16896
  buffer_load_dwordx4 a[20:23], v32, s[24:27], s91 offen offset:0 sc1
  s_waitcnt vmcnt(15)
  s_waitcnt lgkmcnt(6)
  v_mfma_f32_32x32x16_bf16 v[64:79], v[176:179], a[240:243], v[64:79]
  ds_read_b64_tr_b16 v[196:197], v36 offset:20480
  ds_read_b64_tr_b16 v[198:199], v36 offset:20992
  s_waitcnt vmcnt(14)
  v_mfma_f32_32x32x16_bf16 v[64:79], v[180:183], a[244:247], v[64:79]
  ds_read_b64_tr_b16 v[200:201], v36 offset:24576
  ds_read_b64_tr_b16 v[202:203], v36 offset:25088
  s_add_u32 s3, s96, 802816
  s_add_u32 m0, s45, 24576
  s_mov_b32 exec_hi, 0xffff
  buffer_load_dwordx4 v27, s[52:55], s3 offen lds
  s_mov_b32 exec_hi, -1
  s_waitcnt vmcnt(14)
  s_waitcnt lgkmcnt(6)
  v_mfma_f32_32x32x16_bf16 v[64:79], v[184:187], a[248:251], v[64:79]
  ds_read_b64_tr_b16 v[204:205], v36 offset:28672
  ds_read_b64_tr_b16 v[206:207], v36 offset:29184
  s_waitcnt vmcnt(13)
  v_mfma_f32_32x32x16_bf16 v[64:79], v[188:191], a[252:255], v[64:79]
  ds_read_b64_tr_b16 v[176:177], v36 offset:32768
  ds_read_b64_tr_b16 v[178:179], v36 offset:33280
  v_mfma_f32_32x32x16_bf16 v[64:79], v[46:49], v[236:239], v[64:79]
  buffer_load_dwordx4 a[24:27], v31, s[24:27], s91 offen offset:2048 sc1
  s_waitcnt lgkmcnt(6)
  v_mfma_f32_32x32x16_bf16 v[80:95], v[192:195], a[208:211], v[80:95]
  ds_read_b64_tr_b16 v[180:181], v36 offset:36864
  ds_read_b64_tr_b16 v[182:183], v36 offset:37376
  v_mfma_f32_32x32x16_bf16 v[80:95], v[196:199], a[212:215], v[80:95]
  ds_read_b64_tr_b16 v[184:185], v36 offset:40960
  ds_read_b64_tr_b16 v[186:187], v36 offset:41472
  s_nop 3
  v_mul_f32 v208, v64, v64
  v_mul_f32 v209, v65, v65
  v_mul_f32 v210, v66, v66
  s_add_u32 s3, s96, 860160
  s_add_u32 m0, s45, 28672
  s_mov_b32 exec_hi, 0xffff
  buffer_load_dwordx4 v27, s[52:55], s3 offen lds
  s_mov_b32 exec_hi, -1
  s_waitcnt lgkmcnt(6)
  v_mfma_f32_32x32x16_bf16 v[80:95], v[200:203], a[216:219], v[80:95]
  ds_read_b64_tr_b16 v[188:189], v36 offset:45056
  ds_read_b64_tr_b16 v[190:191], v36 offset:45568
  v_mul_f32 v211, v67, v67
  v_mfma_f32_32x32x16_bf16 v[80:95], v[204:207], a[220:223], v[80:95]
  ds_read_b64_tr_b16 v[192:193], v36 offset:49152
  ds_read_b64_tr_b16 v[194:195], v36 offset:49664
  v_fma_f32 v208, v208, v249, v248
  v_fma_f32 v209, v209, v249, v248
  v_fma_f32 v210, v210, v249, v248
  s_waitcnt lgkmcnt(6)
  v_mfma_f32_32x32x16_bf16 v[80:95], v[176:179], a[224:227], v[80:95]
  ds_read_b64_tr_b16 v[196:197], v36 offset:53248
  ds_read_b64_tr_b16 v[198:199], v36 offset:53760
  v_fma_f32 v211, v211, v249, v248
  v_mul_f32 v208, v208, v64
  v_mul_f32 v209, v209, v65
  buffer_load_dwordx4 a[28:31], v32, s[24:27], s91 offen offset:2048 sc1
  v_mfma_f32_32x32x16_bf16 v[80:95], v[180:183], a[228:231], v[80:95]
  ds_read_b64_tr_b16 v[200:201], v36 offset:57344
  ds_read_b64_tr_b16 v[202:203], v36 offset:57856
  v_mul_f32 v210, v210, v66
  s_waitcnt lgkmcnt(6)
  v_mfma_f32_32x32x16_bf16 v[80:95], v[184:187], a[232:235], v[80:95]
  ds_read_b64_tr_b16 v[204:205], v36 offset:61440
  ds_read_b64_tr_b16 v[206:207], v36 offset:61952
  v_mul_f32 v211, v211, v67
  v_exp_f32 v208, v208
  s_barrier
  s_add_u32 s3, s100, 0
  s_add_u32 m0, s45, 32768
  s_mov_b32 exec_hi, 0xffff
  buffer_load_dwordx4 v27, s[52:55], s3 offen lds
  s_mov_b32 exec_hi, -1
  v_mfma_f32_32x32x16_bf16 v[80:95], v[188:191], a[236:239], v[80:95]
  ds_read_b64_tr_b16 v[176:177], v37 offset:16384
  ds_read_b64_tr_b16 v[178:179], v37 offset:16896
  s_waitcnt lgkmcnt(6)
  v_mfma_f32_32x32x16_bf16 v[80:95], v[192:195], a[240:243], v[80:95]
  ds_read_b64_tr_b16 v[180:181], v37 offset:20480
  ds_read_b64_tr_b16 v[182:183], v37 offset:20992
  v_mul_f32 v212, v64, v72
  v_exp_f32 v209, v209
  v_mfma_f32_32x32x16_bf16 v[80:95], v[196:199], a[244:247], v[80:95]
  ds_read_b64_tr_b16 v[184:185], v37 offset:24576
  ds_read_b64_tr_b16 v[186:187], v37 offset:25088
  v_mul_f32 v213, v65, v73
  v_exp_f32 v210, v210
  s_add_u32 s91, s91, 4096
  buffer_load_dwordx4 a[32:35], v31, s[24:27], s91 offen offset:0 sc1
  s_waitcnt lgkmcnt(6)
  v_mfma_f32_32x32x16_bf16 v[80:95], v[200:203], a[248:251], v[80:95]
  ds_read_b64_tr_b16 v[188:189], v37 offset:28672
  ds_read_b64_tr_b16 v[190:191], v37 offset:29184
  v_mul_f32 v214, v66, v74
  v_mfma_f32_32x32x16_bf16 v[80:95], v[204:207], a[252:255], v[80:95]
  ds_read_b64_tr_b16 v[192:193], v37 offset:32768
  ds_read_b64_tr_b16 v[194:195], v37 offset:33280
  v_exp_f32 v211, v211
  v_mul_f32 v215, v67, v75
  s_add_u32 s3, s100, 57344
  s_add_u32 m0, s45, 36864
  s_mov_b32 exec_hi, 0xffff
  buffer_load_dwordx4 v27, s[52:55], s3 offen lds
  s_mov_b32 exec_hi, -1
  v_mfma_f32_32x32x16_bf16 v[80:95], v[48:51], v[236:239], v[80:95]
  v_fma_f32 v208, v208, v250, v250
  v_fma_f32 v209, v209, v250, v250
  v_fma_f32 v210, v210, v250, v250
  v_fma_f32 v211, v211, v250, v250
  v_rcp_f32 v208, v208
  s_waitcnt lgkmcnt(6)
  v_mfma_f32_32x32x16_bf16 v[96:111], v[176:179], a[208:211], v[96:111]
  ds_read_b64_tr_b16 v[196:197], v37 offset:36864
  ds_read_b64_tr_b16 v[198:199], v37 offset:37376
  v_rcp_f32 v209, v209
  v_rcp_f32 v210, v210
  v_mfma_f32_32x32x16_bf16 v[96:111], v[180:183], a[212:215], v[96:111]
  ds_read_b64_tr_b16 v[200:201], v37 offset:40960
  ds_read_b64_tr_b16 v[202:203], v37 offset:41472
  v_rcp_f32 v211, v211
  v_mul_f32 v212, v212, v208
  buffer_load_dwordx4 a[36:39], v32, s[24:27], s91 offen offset:0 sc1
  s_waitcnt lgkmcnt(6)
  v_mfma_f32_32x32x16_bf16 v[96:111], v[184:187], a[216:219], v[96:111]
  ds_read_b64_tr_b16 v[204:205], v37 offset:45056
  ds_read_b64_tr_b16 v[206:207], v37 offset:45568
  v_mul_f32 v213, v213, v209
  v_mfma_f32_32x32x16_bf16 v[96:111], v[188:191], a[220:223], v[96:111]
  ds_read_b64_tr_b16 v[176:177], v37 offset:49152
  ds_read_b64_tr_b16 v[178:179], v37 offset:49664
  v_mul_f32 v214, v214, v210
  v_mul_f32 v215, v215, v211
  v_cvt_pk_bf16_f32 v224, v212, v213
  s_add_u32 s3, s100, 114688
  s_add_u32 m0, s45, 40960
  s_mov_b32 exec_hi, 0xffff
  buffer_load_dwordx4 v27, s[52:55], s3 offen lds
  s_mov_b32 exec_hi, -1
  s_waitcnt lgkmcnt(6)
  v_mfma_f32_32x32x16_bf16 v[96:111], v[192:195], a[224:227], v[96:111]
  ds_read_b64_tr_b16 v[180:181], v37 offset:53248
  ds_read_b64_tr_b16 v[182:183], v37 offset:53760
  v_cvt_pk_bf16_f32 v225, v214, v215
  v_mfma_f32_32x32x16_bf16 v[96:111], v[196:199], a[228:231], v[96:111]
  ds_read_b64_tr_b16 v[184:185], v37 offset:57344
  ds_read_b64_tr_b16 v[186:187], v37 offset:57856
  v_mul_f32 v208, v68, v68
  v_mul_f32 v209, v69, v69
  v_mul_f32 v210, v70, v70
  s_waitcnt lgkmcnt(6)
  v_mfma_f32_32x32x16_bf16 v[96:111], v[200:203], a[232:235], v[96:111]
  ds_read_b64_tr_b16 v[188:189], v37 offset:61440
  ds_read_b64_tr_b16 v[190:191], v37 offset:61952
  v_mul_f32 v211, v71, v71
  v_fma_f32 v208, v208, v249, v248
  v_fma_f32 v209, v209, v249, v248
  buffer_load_dwordx4 a[40:43], v31, s[24:27], s91 offen offset:2048 sc1
  v_mfma_f32_32x32x16_bf16 v[96:111], v[204:207], a[236:239], v[96:111]
  ds_read_b64_tr_b16 v[192:193], v38 offset:16384
  ds_read_b64_tr_b16 v[194:195], v38 offset:16896
  v_fma_f32 v210, v210, v249, v248
  s_waitcnt lgkmcnt(6)
  v_mfma_f32_32x32x16_bf16 v[96:111], v[176:179], a[240:243], v[96:111]
  ds_read_b64_tr_b16 v[196:197], v38 offset:20480
  ds_read_b64_tr_b16 v[198:199], v38 offset:20992
  v_fma_f32 v211, v211, v249, v248
  v_mul_f32 v208, v208, v68
  v_mul_f32 v209, v209, v69
  s_add_u32 s3, s100, 172032
  s_add_u32 m0, s45, 45056
  s_mov_b32 exec_hi, 0xffff
  buffer_load_dwordx4 v27, s[52:55], s3 offen lds
  s_mov_b32 exec_hi, -1
  v_mfma_f32_32x32x16_bf16 v[96:111], v[180:183], a[244:247], v[96:111]
  ds_read_b64_tr_b16 v[200:201], v38 offset:24576
  ds_read_b64_tr_b16 v[202:203], v38 offset:25088
  v_mul_f32 v210, v210, v70
  s_waitcnt lgkmcnt(6)
  v_mfma_f32_32x32x16_bf16 v[96:111], v[184:187], a[248:251], v[96:111]
  ds_read_b64_tr_b16 v[204:205], v38 offset:28672
  ds_read_b64_tr_b16 v[206:207], v38 offset:29184
  v_mul_f32 v211, v211, v71
  v_exp_f32 v208, v208
  v_mfma_f32_32x32x16_bf16 v[96:111], v[188:191], a[252:255], v[96:111]
  ds_read_b64_tr_b16 v[176:177], v38 offset:32768
  ds_read_b64_tr_b16 v[178:179], v38 offset:33280
  v_mul_f32 v212, v68, v76
  v_exp_f32 v209, v209
  buffer_load_dwordx4 a[44:47], v32, s[24:27], s91 offen offset:2048 sc1
  v_mfma_f32_32x32x16_bf16 v[96:111], v[50:53], v[236:239], v[96:111]
  v_mul_f32 v213, v69, v77
  v_exp_f32 v210, v210
  v_mul_f32 v214, v70, v78
  v_exp_f32 v211, v211
  s_waitcnt lgkmcnt(6)
  v_mfma_f32_32x32x16_bf16 v[112:127], v[192:195], a[208:211], v[112:127]
  ds_read_b64_tr_b16 v[180:181], v38 offset:36864
  ds_read_b64_tr_b16 v[182:183], v38 offset:37376
  v_mul_f32 v215, v71, v79
  v_fma_f32 v208, v208, v250, v250
  v_fma_f32 v209, v209, v250, v250
  s_add_u32 s3, s100, 229376
  s_add_u32 m0, s45, 49152
  s_mov_b32 exec_hi, 0xffff
  buffer_load_dwordx4 v27, s[52:55], s3 offen lds
  s_mov_b32 exec_hi, -1
  v_mfma_f32_32x32x16_bf16 v[112:127], v[196:199], a[212:215], v[112:127]
  ds_read_b64_tr_b16 v[184:185], v38 offset:40960
  ds_read_b64_tr_b16 v[186:187], v38 offset:41472
  v_fma_f32 v210, v210, v250, v250
  s_waitcnt lgkmcnt(6)
  v_mfma_f32_32x32x16_bf16 v[112:127], v[200:203], a[216:219], v[112:127]
  ds_read_b64_tr_b16 v[188:189], v38 offset:45056
  ds_read_b64_tr_b16 v[190:191], v38 offset:45568
  v_fma_f32 v211, v211, v250, v250
  v_rcp_f32 v208, v208
  v_mfma_f32_32x32x16_bf16 v[112:127], v[204:207], a[220:223], v[112:127]
  ds_read_b64_tr_b16 v[192:193], v38 offset:49152
  ds_read_b64_tr_b16 v[194:195], v38 offset:49664
  v_rcp_f32 v209, v209
  v_rcp_f32 v210, v210
  s_add_u32 s91, s91, 4096
  buffer_load_dwordx4 a[48:51], v31, s[24:27], s91 offen offset:0 sc1
  s_waitcnt lgkmcnt(6)
  v_mfma_f32_32x32x16_bf16 v[112:127], v[176:179], a[224:227], v[112:127]
  ds_read_b64_tr_b16 v[196:197], v38 offset:53248
  ds_read_b64_tr_b16 v[198:199], v38 offset:53760
  v_rcp_f32 v211, v211
  v_mfma_f32_32x32x16_bf16 v[112:127], v[180:183], a[228:231], v[112:127]
  ds_read_b64_tr_b16 v[200:201], v38 offset:57344
  ds_read_b64_tr_b16 v[202:203], v38 offset:57856
  v_mul_f32 v212, v212, v208
  v_mul_f32 v213, v213, v209
  v_mul_f32 v214, v214, v210
  s_add_u32 s3, s100, 286720
  s_add_u32 m0, s45, 53248
  s_mov_b32 exec_hi, 0xffff
  buffer_load_dwordx4 v27, s[52:55], s3 offen lds
  s_mov_b32 exec_hi, -1
  s_waitcnt lgkmcnt(6)
  v_mfma_f32_32x32x16_bf16 v[112:127], v[184:187], a[232:235], v[112:127]
  ds_read_b64_tr_b16 v[204:205], v38 offset:61440
  ds_read_b64_tr_b16 v[206:207], v38 offset:61952
  v_mul_f32 v215, v215, v211
  v_mfma_f32_32x32x16_bf16 v[112:127], v[188:191], a[236:239], v[112:127]
  s_waitcnt vmcnt(63)
  s_barrier
  ds_read_b64_tr_b16 v[176:177], v39 offset:0
  ds_read_b64_tr_b16 v[178:179], v39 offset:384
  v_cvt_pk_bf16_f32 v226, v212, v213
  v_cvt_pk_bf16_f32 v227, v214, v215
  s_lshl_b32 s47, s40, 10
  s_waitcnt lgkmcnt(6)
  v_mfma_f32_32x32x16_bf16 v[112:127], v[192:195], a[240:243], v[112:127]
  ds_read_b64_tr_b16 v[180:181], v39 offset:32
  ds_read_b64_tr_b16 v[182:183], v39 offset:416
  s_add_u32 s47, s47, s71
  buffer_store_dwordx4 v[224:227], v45, s[24:27], s47 offen sc1
  v_mul_f32 v208, v80, v80
  buffer_load_dwordx4 a[52:55], v32, s[24:27], s91 offen offset:0 sc1
  v_mfma_f32_32x32x16_bf16 v[112:127], v[196:199], a[244:247], v[112:127]
  ds_read_b64_tr_b16 v[184:185], v39 offset:64
  ds_read_b64_tr_b16 v[186:187], v39 offset:448
  v_mul_f32 v209, v81, v81
  s_waitcnt lgkmcnt(6)
  v_mfma_f32_32x32x16_bf16 v[112:127], v[200:203], a[248:251], v[112:127]
  ds_read_b64_tr_b16 v[188:189], v39 offset:4096
  ds_read_b64_tr_b16 v[190:191], v39 offset:4480
  v_mul_f32 v210, v82, v82
  v_mul_f32 v211, v83, v83
  v_fma_f32 v208, v208, v249, v248
  s_add_u32 s3, s100, 344064
  s_add_u32 m0, s45, 57344
  s_mov_b32 exec_hi, 0xffff
  buffer_load_dwordx4 v27, s[52:55], s3 offen lds
  s_mov_b32 exec_hi, -1
  v_mfma_f32_32x32x16_bf16 v[112:127], v[204:207], a[252:255], v[112:127]
  ds_read_b64_tr_b16 v[192:193], v39 offset:4128
  ds_read_b64_tr_b16 v[194:195], v39 offset:4512
  v_fma_f32 v209, v209, v249, v248
  v_mfma_f32_32x32x16_bf16 v[112:127], v[52:55], v[236:239], v[112:127]
  v_fma_f32 v210, v210, v249, v248
  v_fma_f32 v211, v211, v249, v248
  v_mul_f32 v208, v208, v80
  v_mul_f32 v209, v209, v81
  v_mul_f32 v210, v210, v82
  v_mul_f32 v211, v211, v83
  v_exp_f32 v208, v208
  s_waitcnt lgkmcnt(6)
  v_mfma_f32_32x32x16_bf16 v[128:143], v[176:179], a[128:131], 0
  ds_read_b64_tr_b16 v[196:197], v39 offset:4160
  ds_read_b64_tr_b16 v[198:199], v39 offset:4544
  v_mul_f32 v212, v80, v88
  v_exp_f32 v209, v209
  buffer_load_dwordx4 a[56:59], v31, s[24:27], s91 offen offset:2048 sc1
  v_mfma_f32_32x32x16_bf16 v[144:159], v[180:183], a[128:131], 0
  ds_read_b64_tr_b16 v[200:201], v39 offset:8192
  ds_read_b64_tr_b16 v[202:203], v39 offset:8576
  v_mul_f32 v213, v81, v89
  s_waitcnt lgkmcnt(6)
  v_mfma_f32_32x32x16_bf16 v[160:175], v[184:187], a[128:131], 0
  ds_read_b64_tr_b16 v[204:205], v39 offset:8224
  ds_read_b64_tr_b16 v[206:207], v39 offset:8608
  v_exp_f32 v210, v210
  v_mul_f32 v214, v82, v90
  s_add_u32 s3, s100, 401408
  s_add_u32 m0, s45, 61440
  s_mov_b32 exec_hi, 0xffff
  buffer_load_dwordx4 v27, s[52:55], s3 offen lds
  s_mov_b32 exec_hi, -1
  v_mfma_f32_32x32x16_bf16 v[128:143], v[188:191], a[132:135], v[128:143]
  ds_read_b64_tr_b16 v[176:177], v39 offset:8256
  ds_read_b64_tr_b16 v[178:179], v39 offset:8640
  v_exp_f32 v211, v211
  s_waitcnt lgkmcnt(6)
  v_mfma_f32_32x32x16_bf16 v[144:159], v[192:195], a[132:135], v[144:159]
  ds_read_b64_tr_b16 v[180:181], v39 offset:12288
  ds_read_b64_tr_b16 v[182:183], v39 offset:12672
  v_mul_f32 v215, v83, v91
  v_fma_f32 v208, v208, v250, v250
  v_fma_f32 v209, v209, v250, v250
  v_mfma_f32_32x32x16_bf16 v[160:175], v[196:199], a[132:135], v[160:175]
  ds_read_b64_tr_b16 v[184:185], v39 offset:12320
  ds_read_b64_tr_b16 v[186:187], v39 offset:12704
  v_fma_f32 v210, v210, v250, v250
  v_fma_f32 v211, v211, v250, v250
  v_rcp_f32 v208, v208
  buffer_load_dwordx4 a[60:63], v32, s[24:27], s91 offen offset:2048 sc1
  s_waitcnt lgkmcnt(6)
  v_mfma_f32_32x32x16_bf16 v[128:143], v[200:203], a[136:139], v[128:143]
  ds_read_b64_tr_b16 v[188:189], v39 offset:12352
  ds_read_b64_tr_b16 v[190:191], v39 offset:12736
  v_rcp_f32 v209, v209
  v_mfma_f32_32x32x16_bf16 v[144:159], v[204:207], a[136:139], v[144:159]
  ds_read_b64_tr_b16 v[192:193], v39 offset:16384
  ds_read_b64_tr_b16 v[194:195], v39 offset:16768
  v_rcp_f32 v210, v210
  v_rcp_f32 v211, v211
  s_barrier
  s_add_u32 s3, s100, 458752
  s_add_u32 m0, s45, 65536
  s_mov_b32 exec_hi, 0xffff
  buffer_load_dwordx4 v27, s[52:55], s3 offen lds
  s_mov_b32 exec_hi, -1
  s_waitcnt lgkmcnt(6)
  v_mfma_f32_32x32x16_bf16 v[160:175], v[176:179], a[136:139], v[160:175]
  ds_read_b64_tr_b16 v[196:197], v39 offset:16416
  ds_read_b64_tr_b16 v[198:199], v39 offset:16800
  v_mfma_f32_32x32x16_bf16 v[128:143], v[180:183], a[140:143], v[128:143]
  ds_read_b64_tr_b16 v[200:201], v39 offset:16448
  ds_read_b64_tr_b16 v[202:203], v39 offset:16832
  v_mul_f32 v212, v212, v208
  v_mul_f32 v213, v213, v209
  v_mul_f32 v214, v214, v210
  s_waitcnt lgkmcnt(6)
  v_mfma_f32_32x32x16_bf16 v[144:159], v[184:187], a[140:143], v[144:159]
  ds_read_b64_tr_b16 v[204:205], v39 offset:20480
  ds_read_b64_tr_b16 v[206:207], v39 offset:20864
  v_mul_f32 v215, v215, v211
  v_cvt_pk_bf16_f32 v228, v212, v213
  v_cvt_pk_bf16_f32 v229, v214, v215
  s_add_u32 s91, s91, 4096
  buffer_load_dwordx4 a[64:67], v31, s[24:27], s91 offen offset:0 sc1
  v_mfma_f32_32x32x16_bf16 v[160:175], v[188:191], a[140:143], v[160:175]
  ds_read_b64_tr_b16 v[176:177], v39 offset:20512
  ds_read_b64_tr_b16 v[178:179], v39 offset:20896
  v_mul_f32 v208, v84, v84
  s_waitcnt lgkmcnt(6)
  v_mfma_f32_32x32x16_bf16 v[128:143], v[192:195], a[144:147], v[128:143]
  ds_read_b64_tr_b16 v[180:181], v39 offset:20544
  ds_read_b64_tr_b16 v[182:183], v39 offset:20928
  v_mul_f32 v209, v85, v85
  v_mul_f32 v210, v86, v86
  v_mul_f32 v211, v87, v87
  s_add_u32 s3, s100, 516096
  s_add_u32 m0, s45, 69632
  s_mov_b32 exec_hi, 0xffff
  buffer_load_dwordx4 v27, s[52:55], s3 offen lds
  s_mov_b32 exec_hi, -1
  v_mfma_f32_32x32x16_bf16 v[144:159], v[196:199], a[144:147], v[144:159]
  ds_read_b64_tr_b16 v[184:185], v39 offset:24576
  ds_read_b64_tr_b16 v[186:187], v39 offset:24960
  v_fma_f32 v208, v208, v249, v248
  s_waitcnt lgkmcnt(6)
  v_mfma_f32_32x32x16_bf16 v[160:175], v[200:203], a[144:147], v[160:175]
  ds_read_b64_tr_b16 v[188:189], v39 offset:24608
  ds_read_b64_tr_b16 v[190:191], v39 offset:24992
  v_fma_f32 v209, v209, v249, v248
  v_fma_f32 v210, v210, v249, v248
  v_fma_f32 v211, v211, v249, v248
  v_mfma_f32_32x32x16_bf16 v[128:143], v[204:207], a[148:151], v[128:143]
  ds_read_b64_tr_b16 v[192:193], v39 offset:24640
  ds_read_b64_tr_b16 v[194:195], v39 offset:25024
  v_mul_f32 v208, v208, v84
  v_mul_f32 v209, v209, v85
  v_mul_f32 v210, v210, v86
  buffer_load_dwordx4 a[68:71], v32, s[24:27], s91 offen offset:0 sc1
  s_waitcnt lgkmcnt(6)
  v_mfma_f32_32x32x16_bf16 v[144:159], v[176:179], a[148:151], v[144:159]
  ds_read_b64_tr_b16 v[196:197], v39 offset:28672
  ds_read_b64_tr_b16 v[198:199], v39 offset:29056
  v_mul_f32 v211, v211, v87
  v_mfma_f32_32x32x16_bf16 v[160:175], v[180:183], a[148:151], v[160:175]
  ds_read_b64_tr_b16 v[200:201], v39 offset:28704
  ds_read_b64_tr_b16 v[202:203], v39 offset:29088
  v_exp_f32 v208, v208
  v_mul_f32 v212, v84, v92
  s_add_u32 s3, s100, 573440
  s_add_u32 m0, s45, 73728
  s_mov_b32 exec_hi, 0xffff
  buffer_load_dwordx4 v27, s[52:55], s3 offen lds
  s_mov_b32 exec_hi, -1
  s_waitcnt lgkmcnt(6)
  v_mfma_f32_32x32x16_bf16 v[128:143], v[184:187], a[152:155], v[128:143]
  ds_read_b64_tr_b16 v[204:205], v39 offset:28736
  ds_read_b64_tr_b16 v[206:207], v39 offset:29120
  v_exp_f32 v209, v209
  v_mfma_f32_32x32x16_bf16 v[144:159], v[188:191], a[152:155], v[144:159]
  s_waitcnt vmcnt(23)
  s_barrier
  ds_read_b64_tr_b16 v[176:177], v40 offset:0
  ds_read_b64_tr_b16 v[178:179], v40 offset:384
  v_mul_f32 v213, v85, v93
  v_exp_f32 v210, v210
  s_waitcnt lgkmcnt(6)
  v_mfma_f32_32x32x16_bf16 v[160:175], v[192:195], a[152:155], v[160:175]
  ds_read_b64_tr_b16 v[180:181], v40 offset:32
  ds_read_b64_tr_b16 v[182:183], v40 offset:416
  v_mul_f32 v214, v86, v94
  v_exp_f32 v211, v211
  buffer_load_dwordx4 a[72:75], v31, s[24:27], s91 offen offset:2048 sc1
  v_mfma_f32_32x32x16_bf16 v[128:143], v[196:199], a[156:159], v[128:143]
  ds_read_b64_tr_b16 v[184:185], v40 offset:64
  ds_read_b64_tr_b16 v[186:187], v40 offset:448
  v_mul_f32 v215, v87, v95
  s_waitcnt lgkmcnt(6)
  v_mfma_f32_32x32x16_bf16 v[144:159], v[200:203], a[156:159], v[144:159]
  ds_read_b64_tr_b16 v[188:189], v40 offset:4096
  ds_read_b64_tr_b16 v[190:191], v40 offset:4480
  v_fma_f32 v208, v208, v250, v250
  v_fma_f32 v209, v209, v250, v250
  v_fma_f32 v210, v210, v250, v250
  s_add_u32 s3, s100, 630784
  s_add_u32 m0, s45, 77824
  s_mov_b32 exec_hi, 0xffff
  buffer_load_dwordx4 v27, s[52:55], s3 offen lds
  s_mov_b32 exec_hi, -1
  v_mfma_f32_32x32x16_bf16 v[160:175], v[204:207], a[156:159], v[160:175]
  ds_read_b64_tr_b16 v[192:193], v40 offset:4128
  ds_read_b64_tr_b16 v[194:195], v40 offset:4512
  v_fma_f32 v211, v211, v250, v250
  s_waitcnt lgkmcnt(6)
  v_mfma_f32_32x32x16_bf16 v[128:143], v[176:179], a[160:163], v[128:143]
  ds_read_b64_tr_b16 v[196:197], v40 offset:4160
  ds_read_b64_tr_b16 v[198:199], v40 offset:4544
  v_rcp_f32 v208, v208
  v_rcp_f32 v209, v209
  v_mfma_f32_32x32x16_bf16 v[144:159], v[180:183], a[160:163], v[144:159]
  ds_read_b64_tr_b16 v[200:201], v40 offset:8192
  ds_read_b64_tr_b16 v[202:203], v40 offset:8576
  v_rcp_f32 v210, v210
  v_rcp_f32 v211, v211
  buffer_load_dwordx4 a[76:79], v32, s[24:27], s91 offen offset:2048 sc1
  s_waitcnt lgkmcnt(6)
  v_mfma_f32_32x32x16_bf16 v[160:175], v[184:187], a[160:163], v[160:175]
  ds_read_b64_tr_b16 v[204:205], v40 offset:8224
  ds_read_b64_tr_b16 v[206:207], v40 offset:8608
  v_mul_f32 v212, v212, v208
  v_mfma_f32_32x32x16_bf16 v[128:143], v[188:191], a[164:167], v[128:143]
  ds_read_b64_tr_b16 v[176:177], v40 offset:8256
  ds_read_b64_tr_b16 v[178:179], v40 offset:8640
  v_mul_f32 v213, v213, v209
  v_mul_f32 v214, v214, v210
  v_mul_f32 v215, v215, v211
  s_add_u32 s3, s100, 688128
  s_add_u32 m0, s45, 81920
  s_mov_b32 exec_hi, 0xffff
  buffer_load_dwordx4 v27, s[52:55], s3 offen lds
  s_mov_b32 exec_hi, -1
  s_waitcnt lgkmcnt(6)
  v_mfma_f32_32x32x16_bf16 v[144:159], v[192:195], a[164:167], v[144:159]
  ds_read_b64_tr_b16 v[180:181], v40 offset:12288
  ds_read_b64_tr_b16 v[182:183], v40 offset:12672
  v_cvt_pk_bf16_f32 v230, v212, v213
  v_mfma_f32_32x32x16_bf16 v[160:175], v[196:199], a[164:167], v[160:175]
  ds_read_b64_tr_b16 v[184:185], v40 offset:12320
  ds_read_b64_tr_b16 v[186:187], v40 offset:12704
  v_cvt_pk_bf16_f32 v231, v214, v215
  s_lshl_b32 s47, s41, 10
  s_add_u32 s47, s47, s71
  s_waitcnt lgkmcnt(6)
  v_mfma_f32_32x32x16_bf16 v[128:143], v[200:203], a[168:171], v[128:143]
  ds_read_b64_tr_b16 v[188:189], v40 offset:12352
  ds_read_b64_tr_b16 v[190:191], v40 offset:12736
  buffer_store_dwordx4 v[228:231], v45, s[24:27], s47 offen sc1
  v_mul_f32 v208, v96, v96
  v_mul_f32 v209, v97, v97
  s_add_u32 s91, s91, 4096
  buffer_load_dwordx4 a[80:83], v31, s[24:27], s91 offen offset:0 sc1
  v_mfma_f32_32x32x16_bf16 v[144:159], v[204:207], a[168:171], v[144:159]
  ds_read_b64_tr_b16 v[192:193], v40 offset:16384
  ds_read_b64_tr_b16 v[194:195], v40 offset:16768
  v_mul_f32 v210, v98, v98
  s_waitcnt lgkmcnt(6)
  v_mfma_f32_32x32x16_bf16 v[160:175], v[176:179], a[168:171], v[160:175]
  ds_read_b64_tr_b16 v[196:197], v40 offset:16416
  ds_read_b64_tr_b16 v[198:199], v40 offset:16800
  v_mul_f32 v211, v99, v99
  v_fma_f32 v208, v208, v249, v248
  v_fma_f32 v209, v209, v249, v248
  s_add_u32 s3, s100, 745472
  s_add_u32 m0, s45, 86016
  s_mov_b32 exec_hi, 0xffff
  buffer_load_dwordx4 v27, s[52:55], s3 offen lds
  s_mov_b32 exec_hi, -1
  v_mfma_f32_32x32x16_bf16 v[128:143], v[180:183], a[172:175], v[128:143]
  ds_read_b64_tr_b16 v[200:201], v40 offset:16448
  ds_read_b64_tr_b16 v[202:203], v40 offset:16832
  v_fma_f32 v210, v210, v249, v248
  s_waitcnt lgkmcnt(6)
  v_mfma_f32_32x32x16_bf16 v[144:159], v[184:187], a[172:175], v[144:159]
  ds_read_b64_tr_b16 v[204:205], v40 offset:20480
  ds_read_b64_tr_b16 v[206:207], v40 offset:20864
  v_fma_f32 v211, v211, v249, v248
  v_mul_f32 v208, v208, v96
  v_mul_f32 v209, v209, v97
  v_mfma_f32_32x32x16_bf16 v[160:175], v[188:191], a[172:175], v[160:175]
  ds_read_b64_tr_b16 v[176:177], v40 offset:20512
  ds_read_b64_tr_b16 v[178:179], v40 offset:20896
  v_mul_f32 v210, v210, v98
  v_mul_f32 v211, v211, v99
  v_exp_f32 v208, v208
  buffer_load_dwordx4 a[84:87], v32, s[24:27], s91 offen offset:0 sc1
  s_waitcnt lgkmcnt(6)
  v_mfma_f32_32x32x16_bf16 v[128:143], v[192:195], a[176:179], v[128:143]
  ds_read_b64_tr_b16 v[180:181], v40 offset:20544
  ds_read_b64_tr_b16 v[182:183], v40 offset:20928
  v_mul_f32 v212, v96, v104
  v_mfma_f32_32x32x16_bf16 v[144:159], v[196:199], a[176:179], v[144:159]
  ds_read_b64_tr_b16 v[184:185], v40 offset:24576
  ds_read_b64_tr_b16 v[186:187], v40 offset:24960
  v_exp_f32 v209, v209
  v_mul_f32 v213, v97, v105
  s_add_u32 s3, s100, 802816
  s_add_u32 m0, s45, 90112
  s_mov_b32 exec_hi, 0xffff
  buffer_load_dwordx4 v27, s[52:55], s3 offen lds
  s_mov_b32 exec_hi, -1
  s_waitcnt lgkmcnt(6)
  v_mfma_f32_32x32x16_bf16 v[160:175], v[200:203], a[176:179], v[160:175]
  ds_read_b64_tr_b16 v[188:189], v40 offset:24608
  ds_read_b64_tr_b16 v[190:191], v40 offset:24992
  v_exp_f32 v210, v210
  v_mfma_f32_32x32x16_bf16 v[128:143], v[204:207], a[180:183], v[128:143]
  ds_read_b64_tr_b16 v[192:193], v40 offset:24640
  ds_read_b64_tr_b16 v[194:195], v40 offset:25024
  v_mul_f32 v214, v98, v106
  v_exp_f32 v211, v211
  s_waitcnt lgkmcnt(6)
  v_mfma_f32_32x32x16_bf16 v[144:159], v[176:179], a[180:183], v[144:159]
  ds_read_b64_tr_b16 v[196:197], v40 offset:28672
  ds_read_b64_tr_b16 v[198:199], v40 offset:29056
  v_mul_f32 v215, v99, v107
  v_fma_f32 v208, v208, v250, v250
  v_fma_f32 v209, v209, v250, v250
  buffer_load_dwordx4 a[88:91], v31, s[24:27], s91 offen offset:2048 sc1
  v_mfma_f32_32x32x16_bf16 v[160:175], v[180:183], a[180:183], v[160:175]
  ds_read_b64_tr_b16 v[200:201], v40 offset:28704
  ds_read_b64_tr_b16 v[202:203], v40 offset:29088
  v_fma_f32 v210, v210, v250, v250
  s_waitcnt lgkmcnt(6)
  v_mfma_f32_32x32x16_bf16 v[128:143], v[184:187], a[184:187], v[128:143]
  ds_read_b64_tr_b16 v[204:205], v40 offset:28736
  ds_read_b64_tr_b16 v[206:207], v40 offset:29120
  v_fma_f32 v211, v211, v250, v250
  v_rcp_f32 v208, v208
  s_add_u32 m0, s45, 94208
  s_mov_b32 exec_hi, 0xffff
  buffer_load_dwordx4 v29, s[52:55], 0 offen lds
  s_mov_b32 exec_hi, -1
  v_mfma_f32_32x32x16_bf16 v[144:159], v[188:191], a[184:187], v[144:159]
  s_waitcnt vmcnt(17)
  s_barrier
  ds_read_b64_tr_b16 v[176:177], v40 offset:32768
  ds_read_b64_tr_b16 v[178:179], v40 offset:33152
  v_rcp_f32 v209, v209
  s_waitcnt lgkmcnt(6)
  v_mfma_f32_32x32x16_bf16 v[160:175], v[192:195], a[184:187], v[160:175]
  ds_read_b64_tr_b16 v[180:181], v40 offset:32800
  ds_read_b64_tr_b16 v[182:183], v40 offset:33184
  v_rcp_f32 v210, v210
  v_rcp_f32 v211, v211
  v_mfma_f32_32x32x16_bf16 v[128:143], v[196:199], a[188:191], v[128:143]
  ds_read_b64_tr_b16 v[184:185], v40 offset:32832
  ds_read_b64_tr_b16 v[186:187], v40 offset:33216
  v_mul_f32 v212, v212, v208
  v_mul_f32 v213, v213, v209
  v_mul_f32 v214, v214, v210
  buffer_load_dwordx4 a[92:95], v32, s[24:27], s91 offen offset:2048 sc1
  s_waitcnt lgkmcnt(6)
  v_mfma_f32_32x32x16_bf16 v[144:159], v[200:203], a[188:191], v[144:159]
  ds_read_b64_tr_b16 v[188:189], v40 offset:36864
  ds_read_b64_tr_b16 v[190:191], v40 offset:37248
  v_mul_f32 v215, v215, v211
  v_mfma_f32_32x32x16_bf16 v[160:175], v[204:207], a[188:191], v[160:175]
  ds_read_b64_tr_b16 v[192:193], v40 offset:36896
  ds_read_b64_tr_b16 v[194:195], v40 offset:37280
  v_cvt_pk_bf16_f32 v224, v212, v213
  v_cvt_pk_bf16_f32 v225, v214, v215
  v_mul_f32 v208, v100, v100
  s_add_u32 s91, s91, 4096
  buffer_load_dwordx4 a[96:99], v31, s[24:27], s91 offen offset:0 sc1
  s_waitcnt lgkmcnt(6)
  v_mfma_f32_32x32x16_bf16 v[128:143], v[176:179], a[192:195], v[128:143]
  ds_read_b64_tr_b16 v[196:197], v40 offset:36928
  ds_read_b64_tr_b16 v[198:199], v40 offset:37312
  v_mul_f32 v209, v101, v101
  v_mfma_f32_32x32x16_bf16 v[144:159], v[180:183], a[192:195], v[144:159]
  ds_read_b64_tr_b16 v[200:201], v40 offset:40960
  ds_read_b64_tr_b16 v[202:203], v40 offset:41344
  v_mul_f32 v210, v102, v102
  v_mul_f32 v211, v103, v103
  v_fma_f32 v208, v208, v249, v248
  buffer_load_dwordx4 a[100:103], v32, s[24:27], s91 offen offset:0 sc1
  s_waitcnt lgkmcnt(6)
  v_mfma_f32_32x32x16_bf16 v[160:175], v[184:187], a[192:195], v[160:175]
  ds_read_b64_tr_b16 v[204:205], v40 offset:40992
  ds_read_b64_tr_b16 v[206:207], v40 offset:41376
  v_fma_f32 v209, v209, v249, v248
  v_mfma_f32_32x32x16_bf16 v[128:143], v[188:191], a[196:199], v[128:143]
  ds_read_b64_tr_b16 v[176:177], v40 offset:41024
  ds_read_b64_tr_b16 v[178:179], v40 offset:41408
  v_fma_f32 v210, v210, v249, v248
  v_fma_f32 v211, v211, v249, v248
  v_mul_f32 v208, v208, v100
  buffer_load_dwordx4 a[104:107], v31, s[24:27], s91 offen offset:2048 sc1
  s_waitcnt lgkmcnt(6)
  v_mfma_f32_32x32x16_bf16 v[144:159], v[192:195], a[196:199], v[144:159]
  ds_read_b64_tr_b16 v[180:181], v40 offset:45056
  ds_read_b64_tr_b16 v[182:183], v40 offset:45440
  v_mul_f32 v209, v209, v101
  v_mfma_f32_32x32x16_bf16 v[160:175], v[196:199], a[196:199], v[160:175]
  ds_read_b64_tr_b16 v[184:185], v40 offset:45088
  ds_read_b64_tr_b16 v[186:187], v40 offset:45472
  v_mul_f32 v210, v210, v102
  v_mul_f32 v211, v211, v103
  v_exp_f32 v208, v208
  buffer_load_dwordx4 a[108:111], v32, s[24:27], s91 offen offset:2048 sc1
  s_waitcnt lgkmcnt(6)
  v_mfma_f32_32x32x16_bf16 v[128:143], v[200:203], a[200:203], v[128:143]
  ds_read_b64_tr_b16 v[188:189], v40 offset:45120
  ds_read_b64_tr_b16 v[190:191], v40 offset:45504
  v_mul_f32 v212, v100, v108
  v_mfma_f32_32x32x16_bf16 v[144:159], v[204:207], a[200:203], v[144:159]
  ds_read_b64_tr_b16 v[192:193], v40 offset:49152
  ds_read_b64_tr_b16 v[194:195], v40 offset:49536
  v_exp_f32 v209, v209
  v_mul_f32 v213, v101, v109
  s_add_u32 s91, s91, 4096
  buffer_load_dwordx4 a[112:115], v31, s[24:27], s91 offen offset:0 sc1
  s_waitcnt lgkmcnt(6)
  v_mfma_f32_32x32x16_bf16 v[160:175], v[176:179], a[200:203], v[160:175]
  ds_read_b64_tr_b16 v[196:197], v40 offset:53248
  ds_read_b64_tr_b16 v[198:199], v40 offset:53632
  v_exp_f32 v210, v210
  v_mfma_f32_32x32x16_bf16 v[128:143], v[180:183], a[204:207], v[128:143]
  ds_read_b64_tr_b16 v[200:201], v40 offset:57344
  ds_read_b64_tr_b16 v[202:203], v40 offset:57728
  v_mul_f32 v214, v102, v110
  v_exp_f32 v211, v211
  buffer_load_dwordx4 a[116:119], v32, s[24:27], s91 offen offset:0 sc1
  s_waitcnt lgkmcnt(6)
  v_mfma_f32_32x32x16_bf16 v[144:159], v[184:187], a[204:207], v[144:159]
  ds_read_b64_tr_b16 v[204:205], v40 offset:61440
  ds_read_b64_tr_b16 v[206:207], v40 offset:61824
  v_mul_f32 v215, v103, v111
  v_mfma_f32_32x32x16_bf16 v[160:175], v[188:191], a[204:207], v[160:175]
  s_waitcnt vmcnt(7)
  s_barrier
  ds_read_b64_tr_b16 v[176:177], v44 offset:0
  ds_read_b64_tr_b16 v[178:179], v44 offset:384
  v_fma_f32 v208, v208, v250, v250
  v_fma_f32 v209, v209, v250, v250
  v_fma_f32 v210, v210, v250, v250
  buffer_load_dwordx4 a[120:123], v31, s[24:27], s91 offen offset:2048 sc1
  s_waitcnt lgkmcnt(6)
  v_mfma_f32_32x32x16_bf16 v[128:143], v[192:195], a[208:211], v[128:143]
  ds_read_b64_tr_b16 v[180:181], v44 offset:4096
  ds_read_b64_tr_b16 v[182:183], v44 offset:4480
  v_fma_f32 v211, v211, v250, v250
  v_mfma_f32_32x32x16_bf16 v[128:143], v[196:199], a[212:215], v[128:143]
  ds_read_b64_tr_b16 v[184:185], v44 offset:8192
  ds_read_b64_tr_b16 v[186:187], v44 offset:8576
  v_rcp_f32 v208, v208
  v_rcp_f32 v209, v209
  buffer_load_dwordx4 a[124:127], v32, s[24:27], s91 offen offset:2048 sc1
  buffer_load_dwordx4 v[64:67], v31, s[24:27], s83 offen offset:0 sc1
  s_waitcnt lgkmcnt(6)
  v_mfma_f32_32x32x16_bf16 v[128:143], v[200:203], a[216:219], v[128:143]
  ds_read_b64_tr_b16 v[188:189], v44 offset:12288
  ds_read_b64_tr_b16 v[190:191], v44 offset:12672
  v_mfma_f32_32x32x16_bf16 v[128:143], v[204:207], a[220:223], v[128:143]
  ds_read_b64_tr_b16 v[192:193], v44 offset:16384
  ds_read_b64_tr_b16 v[194:195], v44 offset:16768
  v_rcp_f32 v210, v210
  v_rcp_f32 v211, v211
  buffer_load_dwordx4 v[68:71], v32, s[24:27], s83 offen offset:0 sc1
  s_waitcnt lgkmcnt(6)
  v_mfma_f32_32x32x16_bf16 v[128:143], v[176:179], a[224:227], v[128:143]
  ds_read_b64_tr_b16 v[196:197], v44 offset:20480
  ds_read_b64_tr_b16 v[198:199], v44 offset:20864
  v_mul_f32 v212, v212, v208
  v_mul_f32 v213, v213, v209
  v_mfma_f32_32x32x16_bf16 v[128:143], v[180:183], a[228:231], v[128:143]
  ds_read_b64_tr_b16 v[200:201], v44 offset:24576
  ds_read_b64_tr_b16 v[202:203], v44 offset:24960
  v_mul_f32 v214, v214, v210
  v_mul_f32 v215, v215, v211
  v_cvt_pk_bf16_f32 v226, v212, v213
  buffer_load_dwordx4 v[72:75], v31, s[24:27], s83 offen offset:2048 sc1
  s_waitcnt lgkmcnt(6)
  v_mfma_f32_32x32x16_bf16 v[128:143], v[184:187], a[232:235], v[128:143]
  ds_read_b64_tr_b16 v[204:205], v44 offset:28672
  ds_read_b64_tr_b16 v[206:207], v44 offset:29056
  v_cvt_pk_bf16_f32 v227, v214, v215
  s_lshl_b32 s47, s42, 10
  v_mfma_f32_32x32x16_bf16 v[128:143], v[188:191], a[236:239], v[128:143]
  ds_read_b64_tr_b16 v[176:177], v40 offset:49184
  ds_read_b64_tr_b16 v[178:179], v40 offset:49568
  s_add_u32 s47, s47, s71
  buffer_store_dwordx4 v[224:227], v45, s[24:27], s47 offen sc1
  v_mul_f32 v208, v112, v112
  buffer_load_dwordx4 v[76:79], v32, s[24:27], s83 offen offset:2048 sc1
  s_waitcnt lgkmcnt(6)
  v_mfma_f32_32x32x16_bf16 v[128:143], v[192:195], a[240:243], v[128:143]
  ds_read_b64_tr_b16 v[180:181], v40 offset:53280
  ds_read_b64_tr_b16 v[182:183], v40 offset:53664
  v_mul_f32 v209, v113, v113
  v_mul_f32 v210, v114, v114
  v_mfma_f32_32x32x16_bf16 v[128:143], v[196:199], a[244:247], v[128:143]
  ds_read_b64_tr_b16 v[184:185], v40 offset:57376
  ds_read_b64_tr_b16 v[186:187], v40 offset:57760
  v_mul_f32 v211, v115, v115
  v_fma_f32 v208, v208, v249, v248
  v_fma_f32 v209, v209, v249, v248
  s_add_u32 s83, s83, 4096
  buffer_load_dwordx4 v[80:83], v31, s[24:27], s83 offen offset:0 sc1
  s_waitcnt lgkmcnt(6)
  v_mfma_f32_32x32x16_bf16 v[128:143], v[200:203], a[248:251], v[128:143]
  ds_read_b64_tr_b16 v[188:189], v40 offset:61472
  ds_read_b64_tr_b16 v[190:191], v40 offset:61856
  v_fma_f32 v210, v210, v249, v248
  v_fma_f32 v211, v211, v249, v248
  v_mfma_f32_32x32x16_bf16 v[128:143], v[204:207], a[252:255], v[128:143]
  ds_read_b64_tr_b16 v[192:193], v44 offset:32
  ds_read_b64_tr_b16 v[194:195], v44 offset:416
  v_mul_f32 v208, v208, v112
  v_mul_f32 v209, v209, v113
  v_mul_f32 v210, v210, v114
  buffer_load_dwordx4 v[84:87], v32, s[24:27], s83 offen offset:0 sc1
  v_mfma_f32_32x32x16_bf16 v[128:143], v[54:57], v[236:239], v[128:143]
  v_mul_f32 v211, v211, v115
  v_exp_f32 v208, v208
  v_mul_f32 v212, v112, v120
  v_exp_f32 v209, v209
  s_waitcnt lgkmcnt(6)
  v_mfma_f32_32x32x16_bf16 v[144:159], v[176:179], a[208:211], v[144:159]
  ds_read_b64_tr_b16 v[196:197], v44 offset:4128
  ds_read_b64_tr_b16 v[198:199], v44 offset:4512
  v_mul_f32 v213, v113, v121
  v_exp_f32 v210, v210
  buffer_load_dwordx4 v[88:91], v31, s[24:27], s83 offen offset:2048 sc1
  v_mfma_f32_32x32x16_bf16 v[144:159], v[180:183], a[212:215], v[144:159]
  ds_read_b64_tr_b16 v[200:201], v44 offset:8224
  ds_read_b64_tr_b16 v[202:203], v44 offset:8608
  v_mul_f32 v214, v114, v122
  v_exp_f32 v211, v211
  s_waitcnt lgkmcnt(6)
  v_mfma_f32_32x32x16_bf16 v[144:159], v[184:187], a[216:219], v[144:159]
  ds_read_b64_tr_b16 v[204:205], v44 offset:12320
  ds_read_b64_tr_b16 v[206:207], v44 offset:12704
  v_mul_f32 v215, v115, v123
  v_fma_f32 v208, v208, v250, v250
  v_fma_f32 v209, v209, v250, v250
  buffer_load_dwordx4 v[92:95], v32, s[24:27], s83 offen offset:2048 sc1
  v_mfma_f32_32x32x16_bf16 v[144:159], v[188:191], a[220:223], v[144:159]
  ds_read_b64_tr_b16 v[176:177], v44 offset:16416
  ds_read_b64_tr_b16 v[178:179], v44 offset:16800
  v_fma_f32 v210, v210, v250, v250
  v_fma_f32 v211, v211, v250, v250
  s_waitcnt lgkmcnt(6)
  v_mfma_f32_32x32x16_bf16 v[144:159], v[192:195], a[224:227], v[144:159]
  ds_read_b64_tr_b16 v[180:181], v44 offset:20512
  ds_read_b64_tr_b16 v[182:183], v44 offset:20896
  v_rcp_f32 v208, v208
  v_rcp_f32 v209, v209
  v_mfma_f32_32x32x16_bf16 v[144:159], v[196:199], a[228:231], v[144:159]
  ds_read_b64_tr_b16 v[184:185], v44 offset:24608
  ds_read_b64_tr_b16 v[186:187], v44 offset:24992
  v_rcp_f32 v210, v210
  v_rcp_f32 v211, v211
  s_waitcnt lgkmcnt(6)
  v_mfma_f32_32x32x16_bf16 v[144:159], v[200:203], a[232:235], v[144:159]
  ds_read_b64_tr_b16 v[188:189], v44 offset:28704
  ds_read_b64_tr_b16 v[190:191], v44 offset:29088
  v_mul_f32 v212, v212, v208
  v_mul_f32 v213, v213, v209
  v_mul_f32 v214, v214, v210
  v_mfma_f32_32x32x16_bf16 v[144:159], v[204:207], a[236:239], v[144:159]
  ds_read_b64_tr_b16 v[192:193], v40 offset:49216
  ds_read_b64_tr_b16 v[194:195], v40 offset:49600
  v_mul_f32 v215, v215, v211
  v_cvt_pk_bf16_f32 v228, v212, v213
  v_cvt_pk_bf16_f32 v229, v214, v215
  s_waitcnt lgkmcnt(6)
  v_mfma_f32_32x32x16_bf16 v[144:159], v[176:179], a[240:243], v[144:159]
  ds_read_b64_tr_b16 v[196:197], v40 offset:53312
  ds_read_b64_tr_b16 v[198:199], v40 offset:53696
  v_mul_f32 v208, v116, v116
  v_mul_f32 v209, v117, v117
  v_mul_f32 v210, v118, v118
  v_mfma_f32_32x32x16_bf16 v[144:159], v[180:183], a[244:247], v[144:159]
  ds_read_b64_tr_b16 v[200:201], v40 offset:57408
  ds_read_b64_tr_b16 v[202:203], v40 offset:57792
  v_mul_f32 v211, v119, v119
  v_fma_f32 v208, v208, v249, v248
  v_fma_f32 v209, v209, v249, v248
  s_waitcnt lgkmcnt(6)
  v_mfma_f32_32x32x16_bf16 v[144:159], v[184:187], a[248:251], v[144:159]
  ds_read_b64_tr_b16 v[204:205], v40 offset:61504
  ds_read_b64_tr_b16 v[206:207], v40 offset:61888
  v_fma_f32 v210, v210, v249, v248
  v_fma_f32 v211, v211, v249, v248
  v_mul_f32 v208, v208, v116
  v_mfma_f32_32x32x16_bf16 v[144:159], v[188:191], a[252:255], v[144:159]
  ds_read_b64_tr_b16 v[176:177], v44 offset:64
  ds_read_b64_tr_b16 v[178:179], v44 offset:448
  v_mul_f32 v209, v209, v117
  v_mul_f32 v210, v210, v118
  v_mul_f32 v211, v211, v119
  v_mfma_f32_32x32x16_bf16 v[144:159], v[56:59], v[236:239], v[144:159]
  v_exp_f32 v208, v208
  v_mul_f32 v212, v116, v124
  v_exp_f32 v209, v209
  v_mul_f32 v213, v117, v125
  v_exp_f32 v210, v210
  s_waitcnt lgkmcnt(6)
  v_mfma_f32_32x32x16_bf16 v[160:175], v[192:195], a[208:211], v[160:175]
  ds_read_b64_tr_b16 v[180:181], v44 offset:4160
  ds_read_b64_tr_b16 v[182:183], v44 offset:4544
  v_mul_f32 v214, v118, v126
  v_exp_f32 v211, v211
  v_mfma_f32_32x32x16_bf16 v[160:175], v[196:199], a[212:215], v[160:175]
  ds_read_b64_tr_b16 v[184:185], v44 offset:8256
  ds_read_b64_tr_b16 v[186:187], v44 offset:8640
  v_mul_f32 v215, v119, v127
  v_fma_f32 v208, v208, v250, v250
  v_fma_f32 v209, v209, v250, v250
  s_waitcnt lgkmcnt(6)
  v_mfma_f32_32x32x16_bf16 v[160:175], v[200:203], a[216:219], v[160:175]
  ds_read_b64_tr_b16 v[188:189], v44 offset:12352
  ds_read_b64_tr_b16 v[190:191], v44 offset:12736
  v_fma_f32 v210, v210, v250, v250
  v_fma_f32 v211, v211, v250, v250
  v_rcp_f32 v208, v208
  v_mfma_f32_32x32x16_bf16 v[160:175], v[204:207], a[220:223], v[160:175]
  ds_read_b64_tr_b16 v[192:193], v44 offset:16448
  ds_read_b64_tr_b16 v[194:195], v44 offset:16832
  v_rcp_f32 v209, v209
  v_rcp_f32 v210, v210
  s_waitcnt lgkmcnt(6)
  v_mfma_f32_32x32x16_bf16 v[160:175], v[176:179], a[224:227], v[160:175]
  ds_read_b64_tr_b16 v[196:197], v44 offset:20544
  ds_read_b64_tr_b16 v[198:199], v44 offset:20928
  v_rcp_f32 v211, v211
  v_mul_f32 v212, v212, v208
  v_mfma_f32_32x32x16_bf16 v[160:175], v[180:183], a[228:231], v[160:175]
  ds_read_b64_tr_b16 v[200:201], v44 offset:24640
  ds_read_b64_tr_b16 v[202:203], v44 offset:25024
  v_mul_f32 v213, v213, v209
  v_mul_f32 v214, v214, v210
  v_mul_f32 v215, v215, v211
  s_waitcnt lgkmcnt(6)
  v_mfma_f32_32x32x16_bf16 v[160:175], v[184:187], a[232:235], v[160:175]
  ds_read_b64_tr_b16 v[204:205], v44 offset:28736
  ds_read_b64_tr_b16 v[206:207], v44 offset:29120
  v_cvt_pk_bf16_f32 v230, v212, v213
  v_cvt_pk_bf16_f32 v231, v214, v215
  s_lshl_b32 s47, s43, 10
  v_mfma_f32_32x32x16_bf16 v[160:175], v[188:191], a[236:239], v[160:175]
  s_add_u32 s47, s47, s71
  buffer_store_dwordx4 v[228:231], v45, s[24:27], s47 offen sc1
  v_mul_f32 v208, v128, v128
  s_waitcnt lgkmcnt(4)
  v_mfma_f32_32x32x16_bf16 v[160:175], v[192:195], a[240:243], v[160:175]
  v_mul_f32 v209, v129, v129
  v_mul_f32 v210, v130, v130
  v_mul_f32 v211, v131, v131
  v_mfma_f32_32x32x16_bf16 v[160:175], v[196:199], a[244:247], v[160:175]
  v_fma_f32 v208, v208, v249, v248
  v_fma_f32 v209, v209, v249, v248
  v_fma_f32 v210, v210, v249, v248
  s_waitcnt lgkmcnt(0)
  v_mfma_f32_32x32x16_bf16 v[160:175], v[200:203], a[248:251], v[160:175]
  v_fma_f32 v211, v211, v249, v248
  v_mul_f32 v208, v208, v128
  v_mul_f32 v209, v209, v129
  v_mfma_f32_32x32x16_bf16 v[160:175], v[204:207], a[252:255], v[160:175]
  v_mul_f32 v210, v210, v130
  v_mul_f32 v211, v211, v131
  v_exp_f32 v208, v208
  v_mfma_f32_32x32x16_bf16 v[160:175], v[58:61], v[236:239], v[160:175]
  v_mul_f32 v212, v128, v136
  v_exp_f32 v209, v209
  v_mul_f32 v213, v129, v137
  v_exp_f32 v210, v210
  v_mul_f32 v214, v130, v138
  v_exp_f32 v211, v211
  v_mul_f32 v215, v131, v139
  v_fma_f32 v208, v208, v250, v250
  v_fma_f32 v209, v209, v250, v250
  v_fma_f32 v210, v210, v250, v250
  v_fma_f32 v211, v211, v250, v250
  v_rcp_f32 v208, v208
  v_rcp_f32 v209, v209
  v_rcp_f32 v210, v210
  v_rcp_f32 v211, v211
  v_mul_f32 v212, v212, v208
  v_mul_f32 v213, v213, v209
  v_mul_f32 v214, v214, v210
  v_mul_f32 v215, v215, v211
  v_cvt_pk_bf16_f32 v224, v212, v213
  v_cvt_pk_bf16_f32 v225, v214, v215
  v_mul_f32 v208, v132, v132
  v_mul_f32 v209, v133, v133
  v_mul_f32 v210, v134, v134
  v_mul_f32 v211, v135, v135
  v_fma_f32 v208, v208, v249, v248
  v_fma_f32 v209, v209, v249, v248
  v_fma_f32 v210, v210, v249, v248
  v_fma_f32 v211, v211, v249, v248
  v_mul_f32 v208, v208, v132
  v_mul_f32 v209, v209, v133
  v_mul_f32 v210, v210, v134
  v_mul_f32 v211, v211, v135
  v_exp_f32 v208, v208
  v_mul_f32 v212, v132, v140
  v_exp_f32 v209, v209
  v_mul_f32 v213, v133, v141
  v_exp_f32 v210, v210
  v_mul_f32 v214, v134, v142
  v_exp_f32 v211, v211
  v_mul_f32 v215, v135, v143
  v_fma_f32 v208, v208, v250, v250
  v_fma_f32 v209, v209, v250, v250
  v_fma_f32 v210, v210, v250, v250
  v_fma_f32 v211, v211, v250, v250
  v_rcp_f32 v208, v208
  v_rcp_f32 v209, v209
  v_rcp_f32 v210, v210
  v_rcp_f32 v211, v211
  v_mul_f32 v212, v212, v208
  v_mul_f32 v213, v213, v209
  v_mul_f32 v214, v214, v210
  v_mul_f32 v215, v215, v211
  v_cvt_pk_bf16_f32 v226, v212, v213
  v_cvt_pk_bf16_f32 v227, v214, v215
  s_lshl_b32 s47, s68, 10
  s_add_u32 s47, s47, s71
  buffer_store_dwordx4 v[224:227], v45, s[24:27], s47 offen sc1
  v_mul_f32 v208, v144, v144
  v_mul_f32 v209, v145, v145
  v_mul_f32 v210, v146, v146
  v_mul_f32 v211, v147, v147
  v_fma_f32 v208, v208, v249, v248
  v_fma_f32 v209, v209, v249, v248
  v_fma_f32 v210, v210, v249, v248
  v_fma_f32 v211, v211, v249, v248
  v_mul_f32 v208, v208, v144
  v_mul_f32 v209, v209, v145
  v_mul_f32 v210, v210, v146
  v_mul_f32 v211, v211, v147
  v_exp_f32 v208, v208
  v_mul_f32 v212, v144, v152
  v_exp_f32 v209, v209
  v_mul_f32 v213, v145, v153
  v_exp_f32 v210, v210
  v_mul_f32 v214, v146, v154
  v_exp_f32 v211, v211
  v_mul_f32 v215, v147, v155
  v_fma_f32 v208, v208, v250, v250
  v_fma_f32 v209, v209, v250, v250
  v_fma_f32 v210, v210, v250, v250
  v_fma_f32 v211, v211, v250, v250
  v_rcp_f32 v208, v208
  v_rcp_f32 v209, v209
  v_rcp_f32 v210, v210
  v_rcp_f32 v211, v211
  v_mul_f32 v212, v212, v208
  v_mul_f32 v213, v213, v209
  v_mul_f32 v214, v214, v210
  v_mul_f32 v215, v215, v211
  v_cvt_pk_bf16_f32 v228, v212, v213
  v_cvt_pk_bf16_f32 v229, v214, v215
  v_mul_f32 v208, v148, v148
  v_mul_f32 v209, v149, v149
  v_mul_f32 v210, v150, v150
  v_mul_f32 v211, v151, v151
  v_fma_f32 v208, v208, v249, v248
  v_fma_f32 v209, v209, v249, v248
  v_fma_f32 v210, v210, v249, v248
  v_fma_f32 v211, v211, v249, v248
  v_mul_f32 v208, v208, v148
  v_mul_f32 v209, v209, v149
  v_mul_f32 v210, v210, v150
  v_mul_f32 v211, v211, v151
  v_exp_f32 v208, v208
  v_mul_f32 v212, v148, v156
  v_exp_f32 v209, v209
  v_mul_f32 v213, v149, v157
  v_exp_f32 v210, v210
  v_mul_f32 v214, v150, v158
  v_exp_f32 v211, v211
  v_mul_f32 v215, v151, v159
  v_fma_f32 v208, v208, v250, v250
  v_fma_f32 v209, v209, v250, v250
  v_fma_f32 v210, v210, v250, v250
  v_fma_f32 v211, v211, v250, v250
  v_rcp_f32 v208, v208
  v_rcp_f32 v209, v209
  v_rcp_f32 v210, v210
  v_rcp_f32 v211, v211
  v_mul_f32 v212, v212, v208
  v_mul_f32 v213, v213, v209
  v_mul_f32 v214, v214, v210
  v_mul_f32 v215, v215, v211
  v_cvt_pk_bf16_f32 v230, v212, v213
  v_cvt_pk_bf16_f32 v231, v214, v215
  s_lshl_b32 s47, s69, 10
  s_add_u32 s47, s47, s71
  buffer_store_dwordx4 v[228:231], v45, s[24:27], s47 offen sc1
  v_mov_b32 v216, v248
  v_mov_b32 v218, v249
  v_pk_mul_f32 v[176:177], v[160:161], v[160:161]
  v_pk_mul_f32 v[178:179], v[162:163], v[162:163]
  v_pk_mul_f32 v[180:181], v[164:165], v[164:165]
  v_pk_mul_f32 v[182:183], v[166:167], v[166:167]
  v_pk_fma_f32 v[176:177], v[176:177], v[218:219], v[216:217] op_sel_hi:[1,0,0]
  v_pk_fma_f32 v[178:179], v[178:179], v[218:219], v[216:217] op_sel_hi:[1,0,0]
  v_pk_fma_f32 v[180:181], v[180:181], v[218:219], v[216:217] op_sel_hi:[1,0,0]
  v_pk_fma_f32 v[182:183], v[182:183], v[218:219], v[216:217] op_sel_hi:[1,0,0]
  v_pk_mul_f32 v[176:177], v[176:177], v[160:161]
  v_pk_mul_f32 v[178:179], v[178:179], v[162:163]
  v_pk_mul_f32 v[180:181], v[180:181], v[164:165]
  v_pk_mul_f32 v[182:183], v[182:183], v[166:167]
  v_exp_f32 v176, v176
  v_exp_f32 v177, v177
  v_pk_mul_f32 v[184:185], v[160:161], v[168:169]
  v_exp_f32 v178, v178
  v_exp_f32 v179, v179
  v_pk_mul_f32 v[186:187], v[162:163], v[170:171]
  v_exp_f32 v180, v180
  v_exp_f32 v181, v181
  v_pk_mul_f32 v[188:189], v[164:165], v[172:173]
  v_exp_f32 v182, v182
  v_exp_f32 v183, v183
  v_pk_mul_f32 v[190:191], v[166:167], v[174:175]
  v_pk_fma_f32 v[176:177], v[176:177], v[250:251], v[250:251] op_sel_hi:[1,0,0]
  v_pk_fma_f32 v[178:179], v[178:179], v[250:251], v[250:251] op_sel_hi:[1,0,0]
  v_pk_fma_f32 v[180:181], v[180:181], v[250:251], v[250:251] op_sel_hi:[1,0,0]
  v_pk_fma_f32 v[182:183], v[182:183], v[250:251], v[250:251] op_sel_hi:[1,0,0]
  v_rcp_f32 v176, v176
  v_rcp_f32 v177, v177
  v_rcp_f32 v178, v178
  v_rcp_f32 v179, v179
  v_rcp_f32 v180, v180
  v_rcp_f32 v181, v181
  v_rcp_f32 v182, v182
  v_rcp_f32 v183, v183
  v_pk_mul_f32 v[184:185], v[184:185], v[176:177]
  v_pk_mul_f32 v[186:187], v[186:187], v[178:179]
  v_pk_mul_f32 v[188:189], v[188:189], v[180:181]
  v_pk_mul_f32 v[190:191], v[190:191], v[182:183]
  v_cvt_pk_bf16_f32 v224, v184, v185
  v_cvt_pk_bf16_f32 v225, v186, v187
  v_cvt_pk_bf16_f32 v226, v188, v189
  v_cvt_pk_bf16_f32 v227, v190, v191
  s_lshl_b32 s47, s70, 10
  s_add_u32 s47, s47, s71
  buffer_store_dwordx4 v[224:227], v45, s[24:27], s47 offen sc1
  s_and_b32 s62, s38, 1
  s_lshl_b32 s62, s62, 1
  s_lshr_b32 s63, s36, 1
  s_add_u32 s62, s62, s63
  s_lshl_b32 s62, s62, 5
  v_add_u32 v10, s62, v4
  s_bfe_u32 s69, s38, 0x30001
  s_lshr_b32 s63, s69, 2
  s_cmp_lg_u32 s56, 0
  s_cselect_b32 s68, s63, s59
  s_lshl_b32 s62, s69, 3
  s_and_b32 s63, s36, 1
  s_lshl_b32 s63, s63, 2
  s_add_u32 s62, s62, s63
  v_lshl_add_u32 v11, v5, 1, s62
  v_lshlrev_b32 v12, 4, v4
  v_lshrrev_b32 v18, 5, v10
  v_lshl_add_u32 v12, v18, 15, v12
  v_lshl_add_u32 v13, v11, 9, v12
  v_lshlrev_b32 v14, 3, v11
  v_subrev_u32 v15, s68, v14
  v_and_b32 v15, 511, v15
  v_cmp_eq_u32 vcc, 0, v14
  v_cmp_eq_u32 s[64:65], 32, v11
  s_cmp_lg_u32 s56, 0
  s_cselect_b64 vcc, vcc, 0
  s_cselect_b64 s[64:65], s[64:65], 0
  v_mov_b32 v16, 511
  v_cndmask_b32 v15, v15, v16, vcc
  v_cndmask_b32 v15, v15, 0, s[64:65]
  v_lshrrev_b32 v16, 3, v15
  v_lshl_add_u32 v16, v16, 9, v12
  v_bfe_u32 v17, v15, 1, 2
  v_lshl_add_u32 v16, v17, 2, v16
  v_and_b32 v55, 1, v15
  v_lshlrev_b32 v55, 4, v55
  s_lshl_b32 s63, s61, 17
  s_add_u32 s63, s63, 3145728
  buffer_load_dwordx4 v[46:49], v13, s[24:27], s63 offen sc1
  buffer_load_dwordx4 v[50:53], v13, s[24:27], s63 offen offset:512 sc1
  buffer_load_dword v54, v16, s[24:27], s63 offen sc1
  v_add_u32 v56, s58, v10
  v_lshl_add_u32 v56, v56, 3, s57
  v_sub_u32 v8, 0x800, v56
  v_cmp_eq_u32 vcc, 0, v56
  v_mov_b32 v9, 0x400
  s_nop 0
  v_cndmask_b32 v8, v8, v9, vcc
  s_cmp_lg_u32 s59, 0
  s_cselect_b64 vcc, -1, 0
  v_cndmask_b32 v56, v56, v8, vcc
  v_lshlrev_b32 v56, 10, v56
  v_lshl_add_u32 v56, v11, 4, v56
  v_lshlrev_b32 v12, 4, v4
  v_lshl_add_u32 v12, v5, 9, v12
  s_mov_b32 s62, 114688
  v_mad_u32_u24 v57, v18, s62, v12
  v_xor_b32 v18, 1, v18
  v_mad_u32_u24 v58, v18, s62, v12
  v_lshlrev_b32 v41, 4, v1
  s_xor_b32 s62, s36, 1
  s_mul_i32 s62, s62, 12288
  s_add_u32 s62, s62, 32768
  v_add_u32 v37, s62, v41
  s_xor_b32 s62, s36, 2
  s_mul_i32 s62, s62, 12288
  s_add_u32 s62, s62, 36864
  v_add_u32 v38, s62, v41
  s_xor_b32 s62, s36, 3
  s_mul_i32 s62, s62, 12288
  s_add_u32 s62, s62, 40960
  v_add_u32 v39, s62, v41
  s_mul_i32 s62, s36, 12288
  s_add_u32 s62, s62, 32768
  v_add_u32 v40, s62, v41
  s_lshl_b32 s62, s61, 8
  s_lshr_b32 s63, s36, 1
  s_lshl_b32 s63, s63, 7
  s_add_u32 s62, s62, s63
  s_lshl_b32 s63, s60, 3
  s_add_u32 s62, s62, s63
  s_and_b32 s63, s36, 1
  s_lshl_b32 s63, s63, 2
  s_add_u32 s47, s62, s63
  s_lshl_b32 s47, s47, 5
  s_waitcnt vmcnt(3)
  s_mov_b64 exec, 1
  v_mov_b32 v16, 12582912
  v_mov_b32 v17, s39
  buffer_store_dword v17, v16, s[24:27], s47 offen sc1
  s_mov_b64 exec, -1
  s_cmp_lg_u32 s2, 0
  s_cbranch_scc1 L_NC1
  v_lshlrev_b32 v12, 4, v1
  s_lshl_b32 s63, s36, 13
  s_add_u32 s63, s63, 262144
  s_mov_b32 s62, 0
L_NCP:
  buffer_load_dword v176, v12, s[24:27], s63 offen offset:0 sc1
  buffer_load_dword v177, v12, s[24:27], s63 offen offset:1024 sc1
  buffer_load_dword v178, v12, s[24:27], s63 offen offset:2048 sc1
  buffer_load_dword v179, v12, s[24:27], s63 offen offset:3072 sc1
  s_add_u32 s62, s62, 1
  s_waitcnt vmcnt(0)
  v_xor_b32 v176, s39, v176
  v_xor_b32 v177, s39, v177
  v_xor_b32 v178, s39, v178
  v_xor_b32 v179, s39, v179
  v_or3_b32 v176, v176, v177, v178
  v_or_b32 v176, v176, v179
  v_cmp_ne_u32 vcc, 0, v176
  s_cmp_gt_u32 s62, 400000
  s_cbranch_scc1 L_NC1
  s_cbranch_vccz L_NC1
  s_branch L_NCP
L_NC1:
  s_barrier
  s_or_b32 s62, s2, s36
  s_cmp_lg_u32 s62, 0
  s_cbranch_scc1 L_NC
  s_mov_b64 exec, 1
  v_mov_b32 v8, 0
  buffer_store_dword v8, v8, s[28:31], 0 offen sc1
  s_mov_b64 exec, -1
L_NC:
  s_add_u32 s83, s83, 4096
  buffer_load_dwordx4 v[96:99], v31, s[24:27], s83 offen offset:0 sc1
  buffer_load_dwordx4 v[100:103], v32, s[24:27], s83 offen offset:0 sc1
  buffer_load_dwordx4 v[104:107], v31, s[24:27], s83 offen offset:2048 sc1
  buffer_load_dwordx4 v[108:111], v32, s[24:27], s83 offen offset:2048 sc1
  s_add_u32 s83, s83, 4096
  buffer_load_dwordx4 v[112:115], v31, s[24:27], s83 offen offset:0 sc1
  buffer_load_dwordx4 v[116:119], v32, s[24:27], s83 offen offset:0 sc1
  buffer_load_dwordx4 v[120:123], v31, s[24:27], s83 offen offset:2048 sc1
  buffer_load_dwordx4 v[124:127], v32, s[24:27], s83 offen offset:2048 sc1
  s_add_u32 s83, s83, 4096
  buffer_load_dwordx4 a[128:131], v31, s[24:27], s83 offen offset:0 sc1
  buffer_load_dwordx4 a[132:135], v32, s[24:27], s83 offen offset:0 sc1
  buffer_load_dwordx4 a[136:139], v31, s[24:27], s83 offen offset:2048 sc1
  buffer_load_dwordx4 a[140:143], v32, s[24:27], s83 offen offset:2048 sc1
  s_add_u32 s83, s83, 4096
  buffer_load_dwordx4 a[144:147], v31, s[24:27], s83 offen offset:0 sc1
  buffer_load_dwordx4 a[148:151], v32, s[24:27], s83 offen offset:0 sc1
  buffer_load_dwordx4 a[152:155], v31, s[24:27], s83 offen offset:2048 sc1
  buffer_load_dwordx4 a[156:159], v32, s[24:27], s83 offen offset:2048 sc1
  s_lshl_b32 s63, s61, 8
  s_and_b32 s62, s38, 1
  s_lshl_b32 s62, s62, 7
  s_add_u32 s63, s63, s62
  s_lshl_b32 s62, s36, 5
  s_add_u32 s63, s63, s62
  s_lshl_b32 s63, s63, 5
  s_add_u32 s63, s63, 12582912
  v_and_b32 v12, 7, v1
  v_lshlrev_b32 v12, 7, v12
  s_waitcnt vmcnt(17)
  v_lshrrev_b32 v128, v55, v54
  v_lshlrev_b32 v128, 16, v128
  s_cmp_lg_u32 s68, 0
  s_cbranch_scc1 L_SH
  v_and_b32 v129, 0xffff0000, v46
  v_lshlrev_b32 v130, 16, v47
  v_and_b32 v131, 0xffff0000, v47
  v_lshlrev_b32 v132, 16, v48
  v_and_b32 v133, 0xffff0000, v48
  v_lshlrev_b32 v134, 16, v49
  v_and_b32 v135, 0xffff0000, v49
  v_lshlrev_b32 v136, 16, v50
  v_and_b32 v137, 0xffff0000, v50
  v_lshlrev_b32 v138, 16, v51
  v_and_b32 v139, 0xffff0000, v51
  v_lshlrev_b32 v140, 16, v52
  v_and_b32 v141, 0xffff0000, v52
  v_lshlrev_b32 v142, 16, v53
  v_and_b32 v143, 0xffff0000, v53
  s_branch L_SHD
L_SH:
  v_lshlrev_b32 v129, 16, v46
  v_and_b32 v130, 0xffff0000, v46
  v_lshlrev_b32 v131, 16, v47
  v_and_b32 v132, 0xffff0000, v47
  v_lshlrev_b32 v133, 16, v48
  v_and_b32 v134, 0xffff0000, v48
  v_lshlrev_b32 v135, 16, v49
  v_and_b32 v136, 0xffff0000, v49
  v_lshlrev_b32 v137, 16, v50
  v_and_b32 v138, 0xffff0000, v50
  v_lshlrev_b32 v139, 16, v51
  v_and_b32 v140, 0xffff0000, v51
  v_lshlrev_b32 v141, 16, v52
  v_and_b32 v142, 0xffff0000, v52
  v_lshlrev_b32 v143, 16, v53
L_SHD:
  s_mul_i32 s50, s36, 28672
  s_add_u32 s50, s50, s71
  s_mov_b32 s62, 0
POLL_11:
  buffer_load_dword v8, v12, s[24:27], s63 offen sc1
  s_add_u32 s62, s62, 1
  s_waitcnt vmcnt(0)
  v_cmp_ne_u32 vcc, s39, v8
  s_cmp_gt_u32 s62, 400000
  s_cbranch_scc1 PDONE_12
  s_cbranch_vccz PDONE_12
  s_branch POLL_11
PDONE_12:
  buffer_load_dwordx4 v[192:195], v57, s[24:27], s50 offen offset:0 sc1
  buffer_load_dwordx4 v[196:199], v58, s[24:27], s50 offen offset:0 sc1
  buffer_load_dwordx4 v[200:203], v57, s[24:27], s50 offen offset:1024 sc1
  buffer_load_dwordx4 v[204:207], v58, s[24:27], s50 offen offset:1024 sc1
  buffer_load_dwordx4 v[208:211], v57, s[24:27], s50 offen offset:2048 sc1
  buffer_load_dwordx4 v[212:215], v58, s[24:27], s50 offen offset:2048 sc1
  buffer_load_dwordx4 v[216:219], v57, s[24:27], s50 offen offset:3072 sc1
  buffer_load_dwordx4 v[220:223], v58, s[24:27], s50 offen offset:3072 sc1
  s_add_u32 s50, s50, 4096
  buffer_load_dwordx4 v[224:227], v57, s[24:27], s50 offen offset:0 sc1
  buffer_load_dwordx4 v[228:231], v58, s[24:27], s50 offen offset:0 sc1
  buffer_load_dwordx4 v[232:235], v57, s[24:27], s50 offen offset:1024 sc1
  buffer_load_dwordx4 v[236:239], v58, s[24:27], s50 offen offset:1024 sc1
  s_waitcnt vmcnt(11)
  v_mfma_f32_32x32x16_bf16 v[128:143], a[0:3], v[192:195], v[128:143]
  buffer_load_dwordx4 v[240:243], v57, s[24:27], s50 offen offset:2048 sc1
  v_mfma_f32_32x32x16_bf16 v[144:159], a[4:7], v[192:195], 0
  s_waitcnt vmcnt(11)
  v_mfma_f32_32x32x16_bf16 v[160:175], a[0:3], v[196:199], 0
  buffer_load_dwordx4 v[244:247], v58, s[24:27], s50 offen offset:2048 sc1
  v_mfma_f32_32x32x16_bf16 v[176:191], a[4:7], v[196:199], 0
  s_waitcnt vmcnt(11)
  v_mfma_f32_32x32x16_bf16 v[128:143], a[8:11], v[200:203], v[128:143]
  buffer_load_dwordx4 v[248:251], v57, s[24:27], s50 offen offset:3072 sc1
  v_mfma_f32_32x32x16_bf16 v[144:159], a[12:15], v[200:203], v[144:159]
  s_waitcnt vmcnt(11)
  v_mfma_f32_32x32x16_bf16 v[160:175], a[8:11], v[204:207], v[160:175]
  buffer_load_dwordx4 v[192:195], v58, s[24:27], s50 offen offset:3072 sc1
  v_mfma_f32_32x32x16_bf16 v[176:191], a[12:15], v[204:207], v[176:191]
  s_waitcnt vmcnt(11)
  v_mfma_f32_32x32x16_bf16 v[128:143], a[16:19], v[208:211], v[128:143]
  s_add_u32 s50, s50, 4096
  buffer_load_dwordx4 v[196:199], v57, s[24:27], s50 offen offset:0 sc1
  v_mfma_f32_32x32x16_bf16 v[144:159], a[20:23], v[208:211], v[144:159]
  s_waitcnt vmcnt(11)
  v_mfma_f32_32x32x16_bf16 v[160:175], a[16:19], v[212:215], v[160:175]
  buffer_load_dwordx4 v[200:203], v58, s[24:27], s50 offen offset:0 sc1
  v_mfma_f32_32x32x16_bf16 v[176:191], a[20:23], v[212:215], v[176:191]
  s_waitcnt vmcnt(11)
  v_mfma_f32_32x32x16_bf16 v[128:143], a[24:27], v[216:219], v[128:143]
  buffer_load_dwordx4 v[204:207], v57, s[24:27], s50 offen offset:1024 sc1
  v_mfma_f32_32x32x16_bf16 v[144:159], a[28:31], v[216:219], v[144:159]
  s_waitcnt vmcnt(11)
  v_mfma_f32_32x32x16_bf16 v[160:175], a[24:27], v[220:223], v[160:175]
  buffer_load_dwordx4 v[208:211], v58, s[24:27], s50 offen offset:1024 sc1
  v_mfma_f32_32x32x16_bf16 v[176:191], a[28:31], v[220:223], v[176:191]
  s_waitcnt vmcnt(11)
  v_mfma_f32_32x32x16_bf16 v[128:143], a[32:35], v[224:227], v[128:143]
  buffer_load_dwordx4 v[212:215], v57, s[24:27], s50 offen offset:2048 sc1
  v_mfma_f32_32x32x16_bf16 v[144:159], a[36:39], v[224:227], v[144:159]
  s_waitcnt vmcnt(11)
  v_mfma_f32_32x32x16_bf16 v[160:175], a[32:35], v[228:231], v[160:175]
  buffer_load_dwordx4 v[216:219], v58, s[24:27], s50 offen offset:2048 sc1
  v_mfma_f32_32x32x16_bf16 v[176:191], a[36:39], v[228:231], v[176:191]
  s_waitcnt vmcnt(11)
  v_mfma_f32_32x32x16_bf16 v[128:143], a[40:43], v[232:235], v[128:143]
  buffer_load_dwordx4 v[220:223], v57, s[24:27], s50 offen offset:3072 sc1
  v_mfma_f32_32x32x16_bf16 v[144:159], a[44:47], v[232:235], v[144:159]
  s_waitcnt vmcnt(11)
  v_mfma_f32_32x32x16_bf16 v[160:175], a[40:43], v[236:239], v[160:175]
  buffer_load_dwordx4 v[224:227], v58, s[24:27], s50 offen offset:3072 sc1
  v_mfma_f32_32x32x16_bf16 v[176:191], a[44:47], v[236:239], v[176:191]
  s_waitcnt vmcnt(11)
  v_mfma_f32_32x32x16_bf16 v[128:143], a[48:51], v[240:243], v[128:143]
  s_add_u32 s50, s50, 4096
  buffer_load_dwordx4 v[228:231], v57, s[24:27], s50 offen offset:0 sc1
  v_mfma_f32_32x32x16_bf16 v[144:159], a[52:55], v[240:243], v[144:159]
  s_waitcnt vmcnt(11)
  v_mfma_f32_32x32x16_bf16 v[160:175], a[48:51], v[244:247], v[160:175]
  buffer_load_dwordx4 v[232:235], v58, s[24:27], s50 offen offset:0 sc1
  v_mfma_f32_32x32x16_bf16 v[176:191], a[52:55], v[244:247], v[176:191]
  s_waitcnt vmcnt(11)
  v_mfma_f32_32x32x16_bf16 v[128:143], a[56:59], v[248:251], v[128:143]
  buffer_load_dwordx4 v[236:239], v57, s[24:27], s50 offen offset:1024 sc1
  v_mfma_f32_32x32x16_bf16 v[144:159], a[60:63], v[248:251], v[144:159]
  s_waitcnt vmcnt(11)
  v_mfma_f32_32x32x16_bf16 v[160:175], a[56:59], v[192:195], v[160:175]
  buffer_load_dwordx4 v[240:243], v58, s[24:27], s50 offen offset:1024 sc1
  v_mfma_f32_32x32x16_bf16 v[176:191], a[60:63], v[192:195], v[176:191]
  s_waitcnt vmcnt(11)
  v_mfma_f32_32x32x16_bf16 v[128:143], a[64:67], v[196:199], v[128:143]
  buffer_load_dwordx4 v[244:247], v57, s[24:27], s50 offen offset:2048 sc1
  v_mfma_f32_32x32x16_bf16 v[144:159], a[68:71], v[196:199], v[144:159]
  s_waitcnt vmcnt(11)
  v_mfma_f32_32x32x16_bf16 v[160:175], a[64:67], v[200:203], v[160:175]
  buffer_load_dwordx4 v[248:251], v58, s[24:27], s50 offen offset:2048 sc1
  v_mfma_f32_32x32x16_bf16 v[176:191], a[68:71], v[200:203], v[176:191]
  s_waitcnt vmcnt(11)
  v_mfma_f32_32x32x16_bf16 v[128:143], a[72:75], v[204:207], v[128:143]
  buffer_load_dwordx4 v[192:195], v57, s[24:27], s50 offen offset:3072 sc1
  v_mfma_f32_32x32x16_bf16 v[144:159], a[76:79], v[204:207], v[144:159]
  s_waitcnt vmcnt(11)
  v_mfma_f32_32x32x16_bf16 v[160:175], a[72:75], v[208:211], v[160:175]
  buffer_load_dwordx4 v[196:199], v58, s[24:27], s50 offen offset:3072 sc1
  v_mfma_f32_32x32x16_bf16 v[176:191], a[76:79], v[208:211], v[176:191]
  s_waitcnt vmcnt(11)
  v_mfma_f32_32x32x16_bf16 v[128:143], a[80:83], v[212:215], v[128:143]
  s_add_u32 s50, s50, 4096
  buffer_load_dwordx4 v[200:203], v57, s[24:27], s50 offen offset:0 sc1
  v_mfma_f32_32x32x16_bf16 v[144:159], a[84:87], v[212:215], v[144:159]
  s_waitcnt vmcnt(11)
  v_mfma_f32_32x32x16_bf16 v[160:175], a[80:83], v[216:219], v[160:175]
  buffer_load_dwordx4 v[204:207], v58, s[24:27], s50 offen offset:0 sc1
  v_mfma_f32_32x32x16_bf16 v[176:191], a[84:87], v[216:219], v[176:191]
  s_waitcnt vmcnt(11)
  v_mfma_f32_32x32x16_bf16 v[128:143], a[88:91], v[220:223], v[128:143]
  buffer_load_dwordx4 v[208:211], v57, s[24:27], s50 offen offset:1024 sc1
  v_mfma_f32_32x32x16_bf16 v[144:159], a[92:95], v[220:223], v[144:159]
  s_waitcnt vmcnt(11)
  v_mfma_f32_32x32x16_bf16 v[160:175], a[88:91], v[224:227], v[160:175]
  buffer_load_dwordx4 v[212:215], v58, s[24:27], s50 offen offset:1024 sc1
  v_mfma_f32_32x32x16_bf16 v[176:191], a[92:95], v[224:227], v[176:191]
  s_waitcnt vmcnt(11)
  v_mfma_f32_32x32x16_bf16 v[128:143], a[96:99], v[228:231], v[128:143]
  buffer_load_dwordx4 v[216:219], v57, s[24:27], s50 offen offset:2048 sc1
  v_mfma_f32_32x32x16_bf16 v[144:159], a[100:103], v[228:231], v[144:159]
  s_waitcnt vmcnt(11)
  v_mfma_f32_32x32x16_bf16 v[160:175], a[96:99], v[232:235], v[160:175]
  buffer_load_dwordx4 v[220:223], v58, s[24:27], s50 offen offset:2048 sc1
  v_mfma_f32_32x32x16_bf16 v[176:191], a[100:103], v[232:235], v[176:191]
  s_waitcnt vmcnt(11)
  v_mfma_f32_32x32x16_bf16 v[128:143], a[104:107], v[236:239], v[128:143]
  buffer_load_dwordx4 v[224:227], v57, s[24:27], s50 offen offset:3072 sc1
  v_mfma_f32_32x32x16_bf16 v[144:159], a[108:111], v[236:239], v[144:159]
  s_waitcnt vmcnt(11)
  v_mfma_f32_32x32x16_bf16 v[160:175], a[104:107], v[240:243], v[160:175]
  buffer_load_dwordx4 v[228:231], v58, s[24:27], s50 offen offset:3072 sc1
  v_mfma_f32_32x32x16_bf16 v[176:191], a[108:111], v[240:243], v[176:191]
  s_waitcnt vmcnt(11)
  v_mfma_f32_32x32x16_bf16 v[128:143], a[112:115], v[244:247], v[128:143]
  s_add_u32 s50, s50, 4096
  buffer_load_dwordx4 v[232:235], v57, s[24:27], s50 offen offset:0 sc1
  v_mfma_f32_32x32x16_bf16 v[144:159], a[116:119], v[244:247], v[144:159]
  s_waitcnt vmcnt(11)
  v_mfma_f32_32x32x16_bf16 v[160:175], a[112:115], v[248:251], v[160:175]
  buffer_load_dwordx4 v[236:239], v58, s[24:27], s50 offen offset:0 sc1
  v_mfma_f32_32x32x16_bf16 v[176:191], a[116:119], v[248:251], v[176:191]
  s_waitcnt vmcnt(11)
  v_mfma_f32_32x32x16_bf16 v[128:143], a[120:123], v[192:195], v[128:143]
  buffer_load_dwordx4 v[240:243], v57, s[24:27], s50 offen offset:1024 sc1
  v_mfma_f32_32x32x16_bf16 v[144:159], a[124:127], v[192:195], v[144:159]
  s_waitcnt vmcnt(11)
  v_mfma_f32_32x32x16_bf16 v[160:175], a[120:123], v[196:199], v[160:175]
  buffer_load_dwordx4 v[244:247], v58, s[24:27], s50 offen offset:1024 sc1
  v_mfma_f32_32x32x16_bf16 v[176:191], a[124:127], v[196:199], v[176:191]
  s_waitcnt vmcnt(11)
  v_mfma_f32_32x32x16_bf16 v[128:143], v[64:67], v[200:203], v[128:143]
  buffer_load_dwordx4 v[248:251], v57, s[24:27], s50 offen offset:2048 sc1
  v_mfma_f32_32x32x16_bf16 v[144:159], v[68:71], v[200:203], v[144:159]
  s_waitcnt vmcnt(11)
  v_mfma_f32_32x32x16_bf16 v[160:175], v[64:67], v[204:207], v[160:175]
  buffer_load_dwordx4 v[192:195], v58, s[24:27], s50 offen offset:2048 sc1
  v_mfma_f32_32x32x16_bf16 v[176:191], v[68:71], v[204:207], v[176:191]
  s_waitcnt vmcnt(11)
  v_mfma_f32_32x32x16_bf16 v[128:143], v[72:75], v[208:211], v[128:143]
  buffer_load_dwordx4 v[196:199], v57, s[24:27], s50 offen offset:3072 sc1
  v_mfma_f32_32x32x16_bf16 v[144:159], v[76:79], v[208:211], v[144:159]
  s_waitcnt vmcnt(11)
  v_mfma_f32_32x32x16_bf16 v[160:175], v[72:75], v[212:215], v[160:175]
  buffer_load_dwordx4 v[200:203], v58, s[24:27], s50 offen offset:3072 sc1
  v_mfma_f32_32x32x16_bf16 v[176:191], v[76:79], v[212:215], v[176:191]
  s_waitcnt vmcnt(11)
  v_mfma_f32_32x32x16_bf16 v[128:143], v[80:83], v[216:219], v[128:143]
  s_add_u32 s50, s50, 4096
  buffer_load_dwordx4 v[204:207], v57, s[24:27], s50 offen offset:0 sc1
  v_mfma_f32_32x32x16_bf16 v[144:159], v[84:87], v[216:219], v[144:159]
  s_waitcnt vmcnt(11)
  v_mfma_f32_32x32x16_bf16 v[160:175], v[80:83], v[220:223], v[160:175]
  buffer_load_dwordx4 v[208:211], v58, s[24:27], s50 offen offset:0 sc1
  v_mfma_f32_32x32x16_bf16 v[176:191], v[84:87], v[220:223], v[176:191]
  s_waitcnt vmcnt(11)
  v_mfma_f32_32x32x16_bf16 v[128:143], v[88:91], v[224:227], v[128:143]
  buffer_load_dwordx4 v[212:215], v57, s[24:27], s50 offen offset:1024 sc1
  v_mfma_f32_32x32x16_bf16 v[144:159], v[92:95], v[224:227], v[144:159]
  s_waitcnt vmcnt(11)
  v_mfma_f32_32x32x16_bf16 v[160:175], v[88:91], v[228:231], v[160:175]
  buffer_load_dwordx4 v[216:219], v58, s[24:27], s50 offen offset:1024 sc1
  v_mfma_f32_32x32x16_bf16 v[176:191], v[92:95], v[228:231], v[176:191]
  s_waitcnt vmcnt(11)
  v_mfma_f32_32x32x16_bf16 v[128:143], v[96:99], v[232:235], v[128:143]
  buffer_load_dwordx4 v[220:223], v57, s[24:27], s50 offen offset:2048 sc1
  v_mfma_f32_32x32x16_bf16 v[144:159], v[100:103], v[232:235], v[144:159]
  s_waitcnt vmcnt(11)
  v_mfma_f32_32x32x16_bf16 v[160:175], v[96:99], v[236:239], v[160:175]
  buffer_load_dwordx4 v[224:227], v58, s[24:27], s50 offen offset:2048 sc1
  v_mfma_f32_32x32x16_bf16 v[176:191], v[100:103], v[236:239], v[176:191]
  s_waitcnt vmcnt(11)
  v_mfma_f32_32x32x16_bf16 v[128:143], v[104:107], v[240:243], v[128:143]
  buffer_load_dwordx4 v[228:231], v57, s[24:27], s50 offen offset:3072 sc1
  v_mfma_f32_32x32x16_bf16 v[144:159], v[108:111], v[240:243], v[144:159]
  s_waitcnt vmcnt(11)
  v_mfma_f32_32x32x16_bf16 v[160:175], v[104:107], v[244:247], v[160:175]
  buffer_load_dwordx4 v[232:235], v58, s[24:27], s50 offen offset:3072 sc1
  v_mfma_f32_32x32x16_bf16 v[176:191], v[108:111], v[244:247], v[176:191]
  s_waitcnt vmcnt(11)
  v_mfma_f32_32x32x16_bf16 v[128:143], v[112:115], v[248:251], v[128:143]
  v_mfma_f32_32x32x16_bf16 v[144:159], v[116:119], v[248:251], v[144:159]
  s_waitcnt vmcnt(10)
  v_mfma_f32_32x32x16_bf16 v[160:175], v[112:115], v[192:195], v[160:175]
  v_mfma_f32_32x32x16_bf16 v[176:191], v[116:119], v[192:195], v[176:191]
  s_waitcnt vmcnt(9)
  v_mfma_f32_32x32x16_bf16 v[128:143], v[120:123], v[196:199], v[128:143]
  v_mfma_f32_32x32x16_bf16 v[144:159], v[124:127], v[196:199], v[144:159]
  s_waitcnt vmcnt(8)
  v_mfma_f32_32x32x16_bf16 v[160:175], v[120:123], v[200:203], v[160:175]
  v_mfma_f32_32x32x16_bf16 v[176:191], v[124:127], v[200:203], v[176:191]
  s_waitcnt vmcnt(7)
  v_mfma_f32_32x32x16_bf16 v[128:143], a[128:131], v[204:207], v[128:143]
  v_mfma_f32_32x32x16_bf16 v[144:159], a[132:135], v[204:207], v[144:159]
  s_waitcnt vmcnt(6)
  v_mfma_f32_32x32x16_bf16 v[160:175], a[128:131], v[208:211], v[160:175]
  v_mfma_f32_32x32x16_bf16 v[176:191], a[132:135], v[208:211], v[176:191]
  s_waitcnt vmcnt(0)
  v_mfma_f32_32x32x16_bf16 v[176:191], a[140:143], v[216:219], v[176:191]
  v_mfma_f32_32x32x16_bf16 v[176:191], a[148:151], v[224:227], v[176:191]
  v_mfma_f32_32x32x16_bf16 v[176:191], a[156:159], v[232:235], v[176:191]
  v_mfma_f32_32x32x16_bf16 v[160:175], a[136:139], v[216:219], v[160:175]
  v_mfma_f32_32x32x16_bf16 v[160:175], a[144:147], v[224:227], v[160:175]
  s_nop 9
  ds_write_b128 v39, v[176:179] offset:0
  ds_write_b128 v39, v[180:183] offset:1024
  v_mfma_f32_32x32x16_bf16 v[160:175], a[152:155], v[232:235], v[160:175]
  ds_write_b128 v39, v[184:187] offset:2048
  ds_write_b128 v39, v[188:191] offset:3072
  v_mfma_f32_32x32x16_bf16 v[144:159], a[140:143], v[212:215], v[144:159]
  v_mfma_f32_32x32x16_bf16 v[144:159], a[148:151], v[220:223], v[144:159]
  s_nop 7
  ds_write_b128 v38, v[160:163] offset:0
  ds_write_b128 v38, v[164:167] offset:1024
  v_mfma_f32_32x32x16_bf16 v[144:159], a[156:159], v[228:231], v[144:159]
  ds_write_b128 v38, v[168:171] offset:2048
  ds_write_b128 v38, v[172:175] offset:3072
  v_mfma_f32_32x32x16_bf16 v[128:143], a[136:139], v[212:215], v[128:143]
  v_mfma_f32_32x32x16_bf16 v[128:143], a[144:147], v[220:223], v[128:143]
  s_nop 7
  ds_write_b128 v37, v[144:147] offset:0
  ds_write_b128 v37, v[148:151] offset:1024
  v_mfma_f32_32x32x16_bf16 v[128:143], a[152:155], v[228:231], v[128:143]
  ds_write_b128 v37, v[152:155] offset:2048
  ds_write_b128 v37, v[156:159] offset:3072
  s_waitcnt lgkmcnt(0)
  s_barrier
  ds_read_b128 v[144:147], v40 offset:0
  ds_read_b128 v[148:151], v40 offset:1024
  ds_read_b128 v[152:155], v40 offset:2048
  ds_read_b128 v[156:159], v40 offset:3072
  ds_read_b128 v[160:163], v40 offset:4096
  ds_read_b128 v[164:167], v40 offset:5120
  ds_read_b128 v[168:171], v40 offset:6144
  ds_read_b128 v[172:175], v40 offset:7168
  ds_read_b128 v[176:179], v40 offset:8192
  ds_read_b128 v[180:183], v40 offset:9216
  ds_read_b128 v[184:187], v40 offset:10240
  ds_read_b128 v[188:191], v40 offset:11264
  s_waitcnt lgkmcnt(8)
  v_pk_add_f32 v[128:129], v[128:129], v[144:145]
  v_pk_add_f32 v[130:131], v[130:131], v[146:147]
  v_pk_add_f32 v[132:133], v[132:133], v[148:149]
  v_pk_add_f32 v[134:135], v[134:135], v[150:151]
  v_pk_add_f32 v[136:137], v[136:137], v[152:153]
  v_pk_add_f32 v[138:139], v[138:139], v[154:155]
  v_pk_add_f32 v[140:141], v[140:141], v[156:157]
  v_pk_add_f32 v[142:143], v[142:143], v[158:159]
  s_waitcnt lgkmcnt(4)
  v_pk_add_f32 v[128:129], v[128:129], v[160:161]
  v_pk_add_f32 v[130:131], v[130:131], v[162:163]
  v_pk_add_f32 v[132:133], v[132:133], v[164:165]
  v_pk_add_f32 v[134:135], v[134:135], v[166:167]
  v_pk_add_f32 v[136:137], v[136:137], v[168:169]
  v_pk_add_f32 v[138:139], v[138:139], v[170:171]
  v_pk_add_f32 v[140:141], v[140:141], v[172:173]
  v_pk_add_f32 v[142:143], v[142:143], v[174:175]
  s_waitcnt lgkmcnt(0)
  v_pk_add_f32 v[128:129], v[128:129], v[176:177]
  v_pk_add_f32 v[130:131], v[130:131], v[178:179]
  v_pk_add_f32 v[132:133], v[132:133], v[180:181]
  v_pk_add_f32 v[134:135], v[134:135], v[182:183]
  v_pk_add_f32 v[136:137], v[136:137], v[184:185]
  v_pk_add_f32 v[138:139], v[138:139], v[186:187]
  v_pk_add_f32 v[140:141], v[140:141], v[188:189]
  v_pk_add_f32 v[142:143], v[142:143], v[190:191]
  v_cvt_pk_bf16_f32 v64, v128, v129
  v_cvt_pk_bf16_f32 v65, v130, v131
  v_cvt_pk_bf16_f32 v66, v132, v133
  v_cvt_pk_bf16_f32 v67, v134, v135
  buffer_store_dwordx4 v[64:67], v56, s[20:23], 0 offen offset:0
  v_cvt_pk_bf16_f32 v68, v136, v137
  v_cvt_pk_bf16_f32 v69, v138, v139
  v_cvt_pk_bf16_f32 v70, v140, v141
  v_cvt_pk_bf16_f32 v71, v142, v143
  buffer_store_dwordx4 v[68:71], v56, s[20:23], 0 offen offset:16
L_END:
  s_endpgm
.p2align 8
.type L_TBL,@object
L_TBL:
.long 0x3f803f80,0x3f803f80,0x3f803f80,0x3f803f80,0x3f7b3f80,0x3f553f6d,0x3f0e3f35,0x3e483ec4
.long 0x3f6d3f80,0x3ec43f35,0xbec40000,0xbf6dbf35,0x3f553f80,0xbe483ec4,0xbf7bbf35,0xbf0ebf6d
.long 0x3f353f80,0xbf350000,0xbf35bf80,0x3f350000,0x3f0e3f80,0xbf7bbec4,0x3e48bf35,0x3f553f6d
.long 0x3ec43f80,0xbf6dbf35,0x3f6d0000,0xbec43f35,0x3e483f80,0xbf0ebf6d,0x3f553f35,0xbf7bbec4
.long 0x3f80,0xbf80,0x3f80,0xbf80,0xbe483f80,0x3f0ebf6d,0xbf553f35,0x3f7bbec4
.long 0xbec43f80,0x3f6dbf35,0xbf6d0000,0x3ec43f35,0xbf0e3f80,0x3f7bbec4,0xbe48bf35,0xbf553f6d
.long 0xbf353f80,0x3f350000,0x3f35bf80,0xbf350000,0xbf553f80,0x3e483ec4,0x3f7bbf35,0x3f0ebf6d
.long 0xbf6d3f80,0xbec43f35,0x3ec40000,0x3f6dbf35,0xbf7b3f80,0xbf553f6d,0xbf0e3f35,0xbe483ec4
.long 0x3f803f80,0x3f803f80,0x3f803f80,0x3f803f80,0xbe480000,0xbf0ebec4,0xbf55bf35,0xbf7bbf6d
.long 0xbf6dbf80,0xbec4bf35,0x3ec40000,0x3f6d3f35,0x3f0e0000,0x3f7b3f6d,0x3e483f35,0xbf55bec4
.long 0x3f353f80,0xbf350000,0xbf35bf80,0x3f350000,0xbf550000,0xbe48bf6d,0x3f7b3f35,0xbf0e3ec4
.long 0xbec4bf80,0x3f6d3f35,0xbf6d0000,0x3ec4bf35,0x3f7b0000,0xbf553ec4,0x3f0ebf35,0xbe483f6d
.long 0x3f80,0xbf80,0x3f80,0xbf80,0xbf7b0000,0x3f553ec4,0xbf0ebf35,0x3e483f6d
.long 0x3ec4bf80,0xbf6d3f35,0x3f6d0000,0xbec4bf35,0x3f550000,0x3e48bf6d,0xbf7b3f35,0x3f0e3ec4
.long 0xbf353f80,0x3f350000,0x3f35bf80,0xbf350000,0xbf0e0000,0xbf7b3f6d,0xbe483f35,0x3f55bec4
.long 0x3f6dbf80,0x3ec4bf35,0xbec40000,0xbf6d3f35,0x3e480000,0x3f0ebec4,0x3f55bf35,0x3f7bbf6d
.long 0x3f803f80,0x3f803f80,0x3f803f80,0x3f803f80,0xbf7bbf80,0xbf55bf6d,0xbf0ebf35,0xbe48bec4
.long 0x3f6d3f80,0x3ec43f35,0xbec40000,0xbf6dbf35,0xbf55bf80,0x3e48bec4,0x3f7b3f35,0x3f0e3f6d
.long 0x3f353f80,0xbf350000,0xbf35bf80,0x3f350000,0xbf0ebf80,0x3f7b3ec4,0xbe483f35,0xbf55bf6d
.long 0x3ec43f80,0xbf6dbf35,0x3f6d0000,0xbec43f35,0xbe48bf80,0x3f0e3f6d,0xbf55bf35,0x3f7b3ec4
.long 0x3f80,0xbf80,0x3f80,0xbf80,0x3e48bf80,0xbf0e3f6d,0x3f55bf35,0xbf7b3ec4
.long 0xbec43f80,0x3f6dbf35,0xbf6d0000,0x3ec43f35,0x3f0ebf80,0xbf7b3ec4,0x3e483f35,0x3f55bf6d
.long 0xbf353f80,0x3f350000,0x3f35bf80,0xbf350000,0x3f55bf80,0xbe48bec4,0xbf7b3f35,0xbf0e3f6d
.long 0xbf6d3f80,0xbec43f35,0x3ec40000,0x3f6dbf35,0x3f7bbf80,0x3f55bf6d,0x3f0ebf35,0x3e48bec4
.long 0x3f803f80,0x3f803f80,0x3f803f80,0x3f803f80,0x3e480000,0x3f0e3ec4,0x3f553f35,0x3f7b3f6d
.long 0xbf6dbf80,0xbec4bf35,0x3ec40000,0x3f6d3f35,0xbf0e0000,0xbf7bbf6d,0xbe48bf35,0x3f553ec4
.long 0x3f353f80,0xbf350000,0xbf35bf80,0x3f350000,0x3f550000,0x3e483f6d,0xbf7bbf35,0x3f0ebec4
.long 0xbec4bf80,0x3f6d3f35,0xbf6d0000,0x3ec4bf35,0xbf7b0000,0x3f55bec4,0xbf0e3f35,0x3e48bf6d
.long 0x3f80,0xbf80,0x3f80,0xbf80,0x3f7b0000,0xbf55bec4,0x3f0e3f35,0xbe48bf6d
.long 0x3ec4bf80,0xbf6d3f35,0x3f6d0000,0xbec4bf35,0xbf550000,0xbe483f6d,0x3f7bbf35,0xbf0ebec4
.long 0xbf353f80,0x3f350000,0x3f35bf80,0xbf350000,0x3f0e0000,0x3f7bbf6d,0x3e48bf35,0xbf553ec4
.long 0x3f6dbf80,0x3ec4bf35,0xbec40000,0xbf6d3f35,0xbe480000,0xbf0e3ec4,0xbf553f35,0xbf7b3f6d
.long 0xbf803f80,0xbf803f80,0xbf803f80,0xbf803f80,0xbe480000,0xbf0ebec4,0xbf55bf35,0xbf7bbf6d
.long 0xbec40000,0xbf6dbf35,0xbf6dbf80,0xbec4bf35,0xbf0e0000,0xbf7bbf6d,0xbe48bf35,0x3f553ec4
.long 0xbf350000,0xbf35bf80,0x3f350000,0x3f353f80,0xbf550000,0xbe48bf6d,0x3f7b3f35,0xbf0e3ec4
.long 0xbf6d0000,0x3ec4bf35,0x3ec43f80,0xbf6dbf35,0xbf7b0000,0x3f55bec4,0xbf0e3f35,0x3e48bf6d
.long 0xbf800000,0x3f800000,0xbf800000,0x3f800000,0xbf7b0000,0x3f553ec4,0xbf0ebf35,0x3e483f6d
.long 0xbf6d0000,0x3ec43f35,0x3ec4bf80,0xbf6d3f35,0xbf550000,0xbe483f6d,0x3f7bbf35,0xbf0ebec4
.long 0xbf350000,0xbf353f80,0x3f350000,0x3f35bf80,0xbf0e0000,0xbf7b3f6d,0xbe483f35,0x3f55bec4
.long 0xbec40000,0xbf6d3f35,0xbf6d3f80,0xbec43f35,0xbe480000,0xbf0e3ec4,0xbf553f35,0xbf7b3f6d
.long 0xbf803f80,0xbf803f80,0xbf803f80,0xbf803f80,0xbf7bbf80,0xbf55bf6d,0xbf0ebf35,0xbe48bec4
.long 0x3ec40000,0x3f6d3f35,0x3f6d3f80,0x3ec43f35,0x3f553f80,0xbe483ec4,0xbf7bbf35,0xbf0ebf6d
.long 0xbf350000,0xbf35bf80,0x3f350000,0x3f353f80,0xbf0ebf80,0x3f7b3ec4,0xbe483f35,0xbf55bf6d
.long 0x3f6d0000,0xbec43f35,0xbec4bf80,0x3f6d3f35,0x3e483f80,0xbf0ebf6d,0x3f553f35,0xbf7bbec4
.long 0xbf800000,0x3f800000,0xbf800000,0x3f800000,0x3e48bf80,0xbf0e3f6d,0x3f55bf35,0xbf7b3ec4
.long 0x3f6d0000,0xbec4bf35,0xbec43f80,0x3f6dbf35,0xbf0e3f80,0x3f7bbec4,0xbe48bf35,0xbf553f6d
.long 0xbf350000,0xbf353f80,0x3f350000,0x3f35bf80,0x3f55bf80,0xbe48bec4,0xbf7b3f35,0xbf0e3f6d
.long 0x3ec40000,0x3f6dbf35,0x3f6dbf80,0x3ec4bf35,0xbf7b3f80,0xbf553f6d,0xbf0e3f35,0xbe483ec4
.long 0xbf803f80,0xbf803f80,0xbf803f80,0xbf803f80,0x3e480000,0x3f0e3ec4,0x3f553f35,0x3f7b3f6d
.long 0xbec40000,0xbf6dbf35,0xbf6dbf80,0xbec4bf35,0x3f0e0000,0x3f7b3f6d,0x3e483f35,0xbf55bec4
.long 0xbf350000,0xbf35bf80,0x3f350000,0x3f353f80,0x3f550000,0x3e483f6d,0xbf7bbf35,0x3f0ebec4
.long 0xbf6d0000,0x3ec4bf35,0x3ec43f80,0xbf6dbf35,0x3f7b0000,0xbf553ec4,0x3f0ebf35,0xbe483f6d
.long 0xbf800000,0x3f800000,0xbf800000,0x3f800000,0x3f7b0000,0xbf55bec4,0x3f0e3f35,0xbe48bf6d
.long 0xbf6d0000,0x3ec43f35,0x3ec4bf80,0xbf6d3f35,0x3f550000,0x3e48bf6d,0xbf7b3f35,0x3f0e3ec4
.long 0xbf350000,0xbf353f80,0x3f350000,0x3f35bf80,0x3f0e0000,0x3f7bbf6d,0x3e48bf35,0xbf553ec4
.long 0xbec40000,0xbf6d3f35,0xbf6d3f80,0xbec43f35,0x3e480000,0x3f0ebec4,0x3f55bf35,0x3f7bbf6d
.long 0xbf803f80,0xbf803f80,0xbf803f80,0xbf803f80,0x3f7b3f80,0x3f553f6d,0x3f0e3f35,0x3e483ec4
.long 0x3ec40000,0x3f6d3f35,0x3f6d3f80,0x3ec43f35,0xbf55bf80,0x3e48bec4,0x3f7b3f35,0x3f0e3f6d
.long 0xbf350000,0xbf35bf80,0x3f350000,0x3f353f80,0x3f0e3f80,0xbf7bbec4,0x3e48bf35,0x3f553f6d
.long 0x3f6d0000,0xbec43f35,0xbec4bf80,0x3f6d3f35,0xbe48bf80,0x3f0e3f6d,0xbf55bf35,0x3f7b3ec4
.long 0xbf800000,0x3f800000,0xbf800000,0x3f800000,0xbe483f80,0x3f0ebf6d,0xbf553f35,0x3f7bbec4
.long 0x3f6d0000,0xbec4bf35,0xbec43f80,0x3f6dbf35,0x3f0ebf80,0xbf7b3ec4,0x3e483f35,0x3f55bf6d
.long 0xbf350000,0xbf353f80,0x3f350000,0x3f35bf80,0xbf553f80,0x3e483ec4,0x3f7bbf35,0x3f0ebf6d
.long 0x3ec40000,0x3f6dbf35,0x3f6dbf80,0x3ec4bf35,0x3f7bbf80,0x3f55bf6d,0x3f0ebf35,0x3e48bec4
.long 0x3f800000,0x3f800000,0x3f800000,0x3f800000,0x3f800000,0x3f7ffb11,0x3f7fec43,0x3f7fd397
.long 0x3f800000,0x3f7fec43,0x3f7fb10f,0x3f7f4e6d,0x3f800000,0x3f7fd397,0x3f7f4e6d,0x3f7e70b0
.long 0x3f800000,0x3f7fb10f,0x3f7ec46d,0x3f7d3aac,0x3f800000,0x3f7f84ab,0x3f7e1324,0x3f7baccd
.long 0x3f800000,0x3f7f4e6d,0x3f7d3aac,0x3f79c79d,0x3f800000,0x3f7f0e58,0x3f7c3b28,0x3f778bc5
.long 0x3f800000,0x3f7ec46d,0x3f7b14be,0x3f74fa0b,0x3f800000,0x3f7e70b0,0x3f79c79d,0x3f721352
.long 0x3f800000,0x3f7e1324,0x3f7853f8,0x3f6ed89e,0x3f800000,0x3f7dabcc,0x3f76ba07,0x3f6b4b0c
.long 0x3f800000,0x3f7d3aac,0x3f74fa0b,0x3f676bd8,0x3f800000,0x3f7cbfc9,0x3f731447,0x3f633c5a
.long 0x3f800000,0x3f7c3b28,0x3f710908,0x3f5ebe05,0x3f800000,0x3f7baccd,0x3f6ed89e,0x3f59f26a
.long 0x3f800000,0x3f800000,0x3f800000,0x3f800000,0x3f7fb10f,0x3f7f84ab,0x3f7f4e6d,0x3f7f0e58
.long 0x3f7ec46d,0x3f7e1324,0x3f7d3aac,0x3f7c3b28,0x3f7d3aac,0x3f7baccd,0x3f79c79d,0x3f778bc5
.long 0x3f7b14be,0x3f7853f8,0x3f74fa0b,0x3f710908,0x3f7853f8,0x3f740bdd,0x3f6ed89e,0x3f68bf3c
.long 0x3f74fa0b,0x3f6ed89e,0x3f676bd8,0x3f5ebe05,0x3f710908,0x3f68bf3c,0x3f5ebe05,0x3f531849
.long 0x3f6c835e,0x3f61c598,0x3f54db31,0x3f45e403,0x3f676bd8,0x3f59f26a,0x3f49d112,0x3f373a23
.long 0x3f61c598,0x3f514d3d,0x3f3daef9,0x3f273656,0x3f5b941a,0x3f47de65,0x3f3085bb,0x3f15f6d9
.long 0x3f54db31,0x3f3daef9,0x3f226799,0x3f039c3d,0x3f4d9f02,0x3f32c8c9,0x3f13682a,0x3ee0924f
.long 0x3f45e403,0x3f273656,0x3f039c3d,0x3eb8442a,0x3f3daef9,0x3f1b02c6,0x3ee63375,0x3e8e9a22
.long 0x3f800000,0x3f800000,0x3f800000,0x3f800000,0x3f7ec46d,0x3f7e70b0,0x3f7e1324,0x3f7dabcc
.long 0x3f7b14be,0x3f79c79d,0x3f7853f8,0x3f76ba07,0x3f74fa0b,0x3f721352,0x3f6ed89e,0x3f6b4b0c
.long 0x3f6c835e,0x3f676bd8,0x3f61c598,0x3f5b941a,0x3f61c598,0x3f59f26a,0x3f514d3d,0x3f47de65
.long 0x3f54db31,0x3f49d112,0x3f3daef9,0x3f3085bb,0x3f45e403,0x3f373a23,0x3f273656,0x3f15f6d9
.long 0x3f3504f3,0x3f226799,0x3f0e39da,0x3ef15aea,0x3f226799,0x3f0b9a6b,0x3ee63375,0x3eb263ef
.long 0x3f0e39da,0x3ee63375,0x3eac7cd4,0x3e605c13,0x3ef15aea,0x3eb263ef,0x3e605c13,0x3dafb680
.long 0x3ec3ef15,0x3e78cfcc,0x3dc8bd36,0xbd48fb30,0x3e94a031,0x3e09cf86,0xbcc90ab0,0xbe3b6ecf
.long 0x3e47c5c2,0x3cc90ab0,0xbe164083,0xbea09ae5,0x3dc8bd36,0xbdafb680,0xbe888e93,0xbee0924f
.long 0x3f800000,0x3f800000,0x3f800000,0x3f800000,0x3f7d3aac,0x3f7cbfc9,0x3f7c3b28,0x3f7baccd
.long 0x3f74fa0b,0x3f731447,0x3f710908,0x3f6ed89e,0x3f676bd8,0x3f633c5a,0x3f5ebe05,0x3f59f26a
.long 0x3f54db31,0x3f4d9f02,0x3f45e403,0x3f3daef9,0x3f3daef9,0x3f32c8c9,0x3f273656,0x3f1b02c6
.long 0x3f226799,0x3f13682a,0x3f039c3d,0x3ee63375,0x3f039c3d,0x3ee0924f,0x3eb8442a,0x3e8e9a22
.long 0x3ec3ef15,0x3e94a031,0x3e47c5c2,0x3dc8bd36,0x3e78cfcc,0x3e09cf86,0x3cc90ab0,0xbdafb680
.long 0x3dc8bd36,0xbcc90ab0,0xbe164083,0xbe888e93,0xbd48fb30,0xbe3b6ecf,0xbea09ae5,0xbee0924f
.long 0xbe47c5c2,0xbeac7cd4,0xbef15aea,0xbf187fc0,0xbeac7cd4,0xbef6e0cb,0xbf1d7fd1,0xbf3b8f3b
.long 0xbef15aea,0xbf1d7fd1,0xbf3daef9,0xbf584853,0xbf187fc0,0xbf3b8f3b,0xbf584853,0xbf6db293
.long 0x0,0x0,0x0,0x0,0x0,0x3c490e90,0x3cc90ab0,0x3d16c32c
.long 0x0,0x3cc90ab0,0x3d48fb30,0x3d96a905,0x0,0x3d16c32c,0x3d96a905,0x3de1bc2e
.long 0x0,0x3d48fb30,0x3dc8bd36,0x3e164083,0x0,0x3d7b2b74,0x3dfab273,0x3e3b6ecf
.long 0x0,0x3d96a905,0x3e164083,0x3e605c13,0x0,0x3dafb680,0x3e2f10a2,0x3e827dc0
.long 0x0,0x3dc8bd36,0x3e47c5c2,0x3e94a031,0x0,0x3de1bc2e,0x3e605c13,0x3ea68f12
.long 0x0,0x3dfab273,0x3e78cfcc,0x3eb8442a,0x0,0x3e09cf86,0x3e888e93,0x3ec9b953
.long 0x0,0x3e164083,0x3e94a031,0x3edae880,0x0,0x3e22abb6,0x3ea09ae5,0x3eebcbbb
.long 0x0,0x3e2f10a2,0x3eac7cd4,0x3efc5d27,0x0,0x3e3b6ecf,0x3eb8442a,0x3f064b82
.long 0x0,0x0,0x0,0x0,0x3d48fb30,0x3d7b2b74,0x3d96a905,0x3dafb680
.long 0x3dc8bd36,0x3dfab273,0x3e164083,0x3e2f10a2,0x3e164083,0x3e3b6ecf,0x3e605c13,0x3e827dc0
.long 0x3e47c5c2,0x3e78cfcc,0x3e94a031,0x3eac7cd4,0x3e78cfcc,0x3e9aa086,0x3eb8442a,0x3ed53641
.long 0x3e94a031,0x3eb8442a,0x3edae880,0x3efc5d27,0x3eac7cd4,0x3ed53641,0x3efc5d27,0x3f10d3cd
.long 0x3ec3ef15,0x3ef15aea,0x3f0e39da,0x3f226799,0x3edae880,0x3f064b82,0x3f1d7fd1,0x3f32c8c9
.long 0x3ef15aea,0x3f13682a,0x3f2beb4a,0x3f41d870,0x3f039c3d,0x3f1ff6cb,0x3f396842,0x3f4f7a1f
.long 0x3f0e39da,0x3f2beb4a,0x3f45e403,0x3f5b941a,0x3f187fc0,0x3f373a23,0x3f514d3d,0x3f660f88
.long 0x3f226799,0x3f41d870,0x3f5b941a,0x3f6ed89e,0x3f2beb4a,0x3f4bbbf8,0x3f64aa59,0x3f75dec6
.long 0x0,0x0,0x0,0x0,0x3dc8bd36,0x3de1bc2e,0x3dfab273,0x3e09cf86
.long 0x3e47c5c2,0x3e605c13,0x3e78cfcc,0x3e888e93,0x3e94a031,0x3ea68f12,0x3eb8442a,0x3ec9b953
.long 0x3ec3ef15,0x3edae880,0x3ef15aea,0x3f039c3d,0x3ef15aea,0x3f064b82,0x3f13682a,0x3f1ff6cb
.long 0x3f0e39da,0x3f1d7fd1,0x3f2beb4a,0x3f396842,0x3f226799,0x3f32c8c9,0x3f41d870,0x3f4f7a1f
.long 0x3f3504f3,0x3f45e403,0x3f54db31,0x3f61c598,0x3f45e403,0x3f5695e5,0x3f64aa59,0x3f6ff573
.long 0x3f54db31,0x3f64aa59,0x3f710908,0x3f79c79d,0x3f61c598,0x3f6ff573,0x3f79c79d,0x3f7f0e58
.long 0x3f6c835e,0x3f7853f8,0x3f7ec46d,0x3f7fb10f,0x3f74fa0b,0x3f7dabcc,0x3f7fec43,0x3f7baccd
.long 0x3f7b14be,0x3f7fec43,0x3f7d3aac,0x3f731447,0x3f7ec46d,0x3f7f0e58,0x3f76ba07,0x3f660f88
.long 0x0,0x0,0x0,0x0,0x3e164083,0x3e22abb6,0x3e2f10a2,0x3e3b6ecf
.long 0x3e94a031,0x3ea09ae5,0x3eac7cd4,0x3eb8442a,0x3edae880,0x3eebcbbb,0x3efc5d27,0x3f064b82
.long 0x3f0e39da,0x3f187fc0,0x3f226799,0x3f2beb4a,0x3f2beb4a,0x3f373a23,0x3f41d870,0x3f4bbbf8
.long 0x3f45e403,0x3f514d3d,0x3f5b941a,0x3f64aa59,0x3f5b941a,0x3f660f88,0x3f6ed89e,0x3f75dec6
.long 0x3f6c835e,0x3f74fa0b,0x3f7b14be,0x3f7ec46d,0x3f7853f8,0x3f7dabcc,0x3f7fec43,0x3f7f0e58
.long 0x3f7ec46d,0x3f7fec43,0x3f7d3aac,0x3f76ba07,0x3f7fb10f,0x3f7baccd,0x3f731447,0x3f660f88
.long 0x3f7b14be,0x3f710908,0x3f61c598,0x3f4d9f02,0x3f710908,0x3f604621,0x3f49d112,0x3f2e3bde
.long 0x3f61c598,0x3f49d112,0x3f2beb4a,0x3f08f59b,0x3f4d9f02,0x3f2e3bde,0x3f08f59b,0x3ebe1d4a
.long 0x3c00,0x3c00,0x3c00,0x3c00,0x3c00,0x361f3b64,0x39a839a8,0x3b64361f
.long 0x3c00,0x39a839a8,0x3c000000,0x39a8b9a8,0x3c00,0x3b64361f,0x39a8b9a8,0xb61fbb64
.long 0x3c00,0x3c000000,0xbc00,0xbc000000,0x3c00,0x3b64b61f,0xb9a8b9a8,0xb61f3b64
.long 0x3c00,0x39a8b9a8,0xbc000000,0x39a839a8,0x3c00,0x361fbb64,0xb9a839a8,0x3b64b61f
.long 0x3c00,0xbc00,0x3c00,0xbc00,0x3c00,0xb61fbb64,0x39a839a8,0xbb64b61f
.long 0x3c00,0xb9a8b9a8,0x3c000000,0xb9a839a8,0x3c00,0xbb64b61f,0x39a8b9a8,0x361f3b64
.long 0x3c00,0xbc000000,0xbc00,0x3c000000,0x3c00,0xbb64361f,0xb9a8b9a8,0x361fbb64
.long 0x3c00,0xb9a839a8,0xbc000000,0xb9a8b9a8,0x3c00,0xb61f3b64,0xb9a839a8,0xbb64361f
.long 0x3c00,0x3c00,0x3c00,0x3c00,0x3c000000,0x3b64b61f,0x39a8b9a8,0x361fbb64
.long 0xbc00,0xb9a8b9a8,0xbc000000,0xb9a839a8,0xbc000000,0xb61f3b64,0x39a839a8,0x3b64b61f
.long 0x3c00,0x3c000000,0xbc00,0xbc000000,0x3c000000,0xb61fbb64,0xb9a839a8,0x3b64361f
.long 0xbc00,0xb9a839a8,0x3c000000,0xb9a8b9a8,0xbc000000,0x3b64361f,0xb9a8b9a8,0x361f3b64
.long 0x3c00,0xbc00,0x3c00,0xbc00,0x3c000000,0xbb64361f,0x39a8b9a8,0xb61f3b64
.long 0xbc00,0x39a839a8,0xbc000000,0x39a8b9a8,0xbc000000,0x361fbb64,0x39a839a8,0xbb64361f
.long 0x3c00,0xbc000000,0xbc00,0x3c000000,0x3c000000,0x361f3b64,0xb9a839a8,0xbb64b61f
.long 0xbc00,0x39a8b9a8,0x3c000000,0x39a839a8,0xbc000000,0xbb64b61f,0xb9a8b9a8,0xb61fbb64
.long 0x3c00,0x3c00,0x3c00,0x3c00,0xbc00,0xb61fbb64,0xb9a8b9a8,0xbb64b61f
.long 0x3c00,0x39a839a8,0x3c000000,0x39a8b9a8,0xbc00,0xbb64b61f,0xb9a839a8,0x361f3b64
.long 0x3c00,0x3c000000,0xbc00,0xbc000000,0xbc00,0xbb64361f,0x39a839a8,0x361fbb64
.long 0x3c00,0x39a8b9a8,0xbc000000,0x39a839a8,0xbc00,0xb61f3b64,0x39a8b9a8,0xbb64361f
.long 0x3c00,0xbc00,0x3c00,0xbc00,0xbc00,0x361f3b64,0xb9a8b9a8,0x3b64361f
.long 0x3c00,0xb9a8b9a8,0x3c000000,0xb9a839a8,0xbc00,0x3b64361f,0xb9a839a8,0xb61fbb64
.long 0x3c00,0xbc000000,0xbc00,0x3c000000,0xbc00,0x3b64b61f,0x39a839a8,0xb61f3b64
.long 0x3c00,0xb9a839a8,0xbc000000,0xb9a8b9a8,0xbc00,0x361fbb64,0x39a8b9a8,0x3b64b61f
.long 0x3c00,0x3c00,0x3c00,0x3c00,0xbc000000,0xbb64361f,0xb9a839a8,0xb61f3b64
.long 0xbc00,0xb9a8b9a8,0xbc000000,0xb9a839a8,0x3c000000,0x361fbb64,0xb9a8b9a8,0xbb64361f
.long 0x3c00,0x3c000000,0xbc00,0xbc000000,0xbc000000,0x361f3b64,0x39a8b9a8,0xbb64b61f
.long 0xbc00,0xb9a839a8,0x3c000000,0xb9a8b9a8,0x3c000000,0xbb64b61f,0x39a839a8,0xb61fbb64
.long 0x3c00,0xbc00,0x3c00,0xbc00,0xbc000000,0x3b64b61f,0xb9a839a8,0x361fbb64
.long 0xbc00,0x39a839a8,0xbc000000,0x39a8b9a8,0x3c000000,0xb61f3b64,0xb9a8b9a8,0x3b64b61f
.long 0x3c00,0xbc000000,0xbc00,0x3c000000,0xbc000000,0xb61fbb64,0x39a8b9a8,0x3b64361f
.long 0xbc00,0x39a8b9a8,0x3c000000,0x39a839a8,0x3c000000,0x3b64361f,0x39a839a8,0x361f3b64
.long 0x3c000000,0x3c000000,0x3c000000,0x3c000000,0x3c000000,0x3b64b61f,0x39a8b9a8,0x361fbb64
.long 0x3c000000,0x39a8b9a8,0xbc00,0xb9a8b9a8,0x3c000000,0x361fbb64,0xb9a8b9a8,0xbb64361f
.long 0x3c000000,0xbc00,0xbc000000,0x3c00,0x3c000000,0xb61fbb64,0xb9a839a8,0x3b64361f
.long 0x3c000000,0xb9a8b9a8,0x3c00,0x39a8b9a8,0x3c000000,0xbb64b61f,0x39a839a8,0xb61fbb64
.long 0xbc000000,0x3c000000,0xbc000000,0x3c000000,0xbc000000,0x3b64b61f,0xb9a839a8,0x361fbb64
.long 0xbc000000,0x39a8b9a8,0x3c00,0xb9a8b9a8,0xbc000000,0x361fbb64,0x39a839a8,0xbb64361f
.long 0xbc000000,0xbc00,0x3c000000,0x3c00,0xbc000000,0xb61fbb64,0x39a8b9a8,0x3b64361f
.long 0xbc000000,0xb9a8b9a8,0xbc00,0x39a8b9a8,0xbc000000,0xbb64b61f,0xb9a8b9a8,0xb61fbb64
.long 0x3c000000,0x3c000000,0x3c000000,0x3c000000,0xbc00,0xb61fbb64,0xb9a8b9a8,0xbb64b61f
.long 0xbc000000,0xb9a839a8,0x3c00,0x39a839a8,0x3c00,0x3b64361f,0x39a8b9a8,0xb61fbb64
.long 0x3c000000,0xbc00,0xbc000000,0x3c00,0xbc00,0xbb64361f,0x39a839a8,0x361fbb64
.long 0xbc000000,0x39a839a8,0xbc00,0xb9a839a8,0x3c00,0x361fbb64,0xb9a839a8,0x3b64b61f
.long 0xbc000000,0x3c000000,0xbc000000,0x3c000000,0x3c00,0xb61fbb64,0x39a839a8,0xbb64b61f
.long 0x3c000000,0xb9a839a8,0xbc00,0x39a839a8,0xbc00,0x3b64361f,0xb9a839a8,0xb61fbb64
.long 0xbc000000,0xbc00,0x3c000000,0x3c00,0x3c00,0xbb64361f,0xb9a8b9a8,0x361fbb64
.long 0x3c000000,0x39a839a8,0x3c00,0xb9a839a8,0xbc00,0x361fbb64,0x39a8b9a8,0x3b64b61f
.long 0x3c000000,0x3c000000,0x3c000000,0x3c000000,0xbc000000,0xbb64361f,0xb9a839a8,0xb61f3b64
.long 0x3c000000,0x39a8b9a8,0xbc00,0xb9a8b9a8,0xbc000000,0xb61f3b64,0x39a839a8,0x3b64b61f
.long 0x3c000000,0xbc00,0xbc000000,0x3c00,0xbc000000,0x361f3b64,0x39a8b9a8,0xbb64b61f
.long 0x3c000000,0xb9a8b9a8,0x3c00,0x39a8b9a8,0xbc000000,0x3b64361f,0xb9a8b9a8,0x361f3b64
.long 0xbc000000,0x3c000000,0xbc000000,0x3c000000,0x3c000000,0xbb64361f,0x39a8b9a8,0xb61f3b64
.long 0xbc000000,0x39a8b9a8,0x3c00,0xb9a8b9a8,0x3c000000,0xb61f3b64,0xb9a8b9a8,0x3b64b61f
.long 0xbc000000,0xbc00,0x3c000000,0x3c00,0x3c000000,0x361f3b64,0xb9a839a8,0xbb64b61f
.long 0xbc000000,0xb9a8b9a8,0xbc00,0x39a8b9a8,0x3c000000,0x3b64361f,0x39a839a8,0x361f3b64
.long 0x3c000000,0x3c000000,0x3c000000,0x3c000000,0x3c00,0x361f3b64,0x39a839a8,0x3b64361f
.long 0xbc000000,0xb9a839a8,0x3c00,0x39a839a8,0xbc00,0xbb64b61f,0xb9a839a8,0x361f3b64
.long 0x3c000000,0xbc00,0xbc000000,0x3c00,0x3c00,0x3b64b61f,0xb9a8b9a8,0xb61f3b64
.long 0xbc000000,0x39a839a8,0xbc00,0xb9a839a8,0xbc00,0xb61f3b64,0x39a8b9a8,0xbb64361f
.long 0xbc000000,0x3c000000,0xbc000000,0x3c000000,0xbc00,0x361f3b64,0xb9a8b9a8,0x3b64361f
.long 0x3c000000,0xb9a839a8,0xbc00,0x39a839a8,0x3c00,0xbb64b61f,0x39a8b9a8,0x361f3b64
.long 0xbc000000,0xbc00,0x3c000000,0x3c00,0xbc00,0x3b64b61f,0x39a839a8,0xb61f3b64
.long 0x3c000000,0x39a839a8,0x3c00,0xb9a839a8,0x3c00,0xb61f3b64,0xb9a839a8,0xbb64361f
.long 0x3c00,0x3b64,0x39a8,0x361f,0x3c00,0x39a8,0x0,0xb9a8
.long 0x3c00,0x361f,0xb9a8,0xbb64,0x3c00,0x0,0xbc00,0x0
.long 0x3c00,0xb61f,0xb9a8,0x3b64,0x3c00,0xb9a8,0x0,0x39a8
.long 0x3c00,0xbb64,0x39a8,0xb61f,0x3c00,0xbc00,0x3c00,0xbc00
.long 0x3c000000,0x3bd90000,0x3b640000,0x3aa70000,0x3c000000,0x3aa70000,0x361f0000,0xb23e0000
.long 0x3c000000,0x38720000,0xb61f0000,0xbbd90000,0x3c000000,0x323e0000,0xbb640000,0xb8720000
.long 0x3c000000,0xb23e0000,0xbb640000,0x38720000,0x3c000000,0xb8720000,0xb61f0000,0x3bd90000
.long 0x3c000000,0xbaa70000,0x361f0000,0x323e0000,0x3c000000,0xbbd90000,0x3b640000,0xbaa70000
.long 0x0,0xb61f,0xb9a8,0xbb64,0xbc00,0xb9a8,0x0,0x39a8
.long 0x0,0x3b64,0x39a8,0xb61f,0x3c00,0x0,0xbc00,0x0
.long 0x0,0xbb64,0x39a8,0x361f,0xbc00,0x39a8,0x0,0xb9a8
.long 0x0,0x361f,0xb9a8,0x3b64,0x3c00,0xbc00,0x3c00,0xbc00
.long 0x39a80000,0x38720000,0x361f0000,0x323e0000,0xb9a80000,0xbbd90000,0xbb640000,0xb8720000
.long 0xb9a80000,0x323e0000,0x3b640000,0x3aa70000,0x39a80000,0x3aa70000,0xb61f0000,0xbbd90000
.long 0x39a80000,0xbaa70000,0xb61f0000,0x3bd90000,0xb9a80000,0xb23e0000,0x3b640000,0xbaa70000
.long 0xb9a80000,0x3bd90000,0xbb640000,0x38720000,0x39a80000,0xb8720000,0x361f0000,0xb23e0000
.long 0xbc00,0xbb64,0xb9a8,0xb61f,0x3c00,0x39a8,0x0,0xb9a8
.long 0xbc00,0xb61f,0x39a8,0x3b64,0x3c00,0x0,0xbc00,0x0
.long 0xbc00,0x361f,0x39a8,0xbb64,0x3c00,0xb9a8,0x0,0x39a8
.long 0xbc00,0x3b64,0xb9a8,0x361f,0x3c00,0xbc00,0x3c00,0xbc00
.long 0x0,0xb23e0000,0xb61f0000,0xb8720000,0x0,0x38720000,0x3b640000,0x3bd90000
.long 0x0,0xbaa70000,0xbb640000,0xb23e0000,0x0,0x3bd90000,0x361f0000,0xbaa70000
.long 0x0,0xbbd90000,0x361f0000,0x3aa70000,0x0,0x3aa70000,0xbb640000,0x323e0000
.long 0x0,0xb8720000,0x3b640000,0xbbd90000,0x0,0x323e0000,0xb61f0000,0x38720000
.long 0x0,0x361f,0x39a8,0x3b64,0xbc00,0xb9a8,0x0,0x39a8
.long 0x0,0xbb64,0xb9a8,0x361f,0x3c00,0x0,0xbc00,0x0
.long 0x0,0x3b64,0xb9a8,0xb61f,0xbc00,0x39a8,0x0,0xb9a8
.long 0x0,0xb61f,0x39a8,0xbb64,0x3c00,0xbc00,0x3c00,0xbc00
.long 0xb9a80000,0xbaa70000,0xbb640000,0xbbd90000,0x39a80000,0x323e0000,0xb61f0000,0xbaa70000
.long 0x39a80000,0x3bd90000,0x361f0000,0xb8720000,0xb9a80000,0x38720000,0x3b640000,0xb23e0000
.long 0xb9a80000,0xb8720000,0x3b640000,0x323e0000,0x39a80000,0xbbd90000,0x361f0000,0x38720000
.long 0x39a80000,0xb23e0000,0xb61f0000,0x3aa70000,0xb9a80000,0x3aa70000,0xbb640000,0x3bd90000
.long 0x0,0xb61f,0xb9a8,0xbb64,0x0,0xb9a8,0xbc00,0xb9a8
.long 0x0,0xbb64,0xb9a8,0x361f,0x0,0xbc00,0x0,0x3c00
.long 0x0,0xbb64,0x39a8,0x361f,0x0,0xb9a8,0x3c00,0xb9a8
.long 0x0,0xb61f,0x39a8,0xbb64,0x0,0x0,0x0,0x0
.long 0x0,0xb23e0000,0xb61f0000,0xb8720000,0x0,0xb8720000,0xbb640000,0xbbd90000
.long 0x0,0xbaa70000,0xbb640000,0xb23e0000,0x0,0xbbd90000,0xb61f0000,0x3aa70000
.long 0x0,0xbbd90000,0x361f0000,0x3aa70000,0x0,0xbaa70000,0x3b640000,0xb23e0000
.long 0x0,0xb8720000,0x3b640000,0xbbd90000,0x0,0xb23e0000,0x361f0000,0xb8720000
.long 0xbc00,0xbb64,0xb9a8,0xb61f,0x0,0x39a8,0x3c00,0x39a8
.long 0x3c00,0x361f,0xb9a8,0xbb64,0x0,0xbc00,0x0,0x3c00
.long 0xbc00,0x361f,0x39a8,0xbb64,0x0,0x39a8,0xbc00,0x39a8
.long 0x3c00,0xbb64,0x39a8,0xb61f,0x0,0x0,0x0,0x0
.long 0xb9a80000,0xbaa70000,0xbb640000,0xbbd90000,0xb9a80000,0xb23e0000,0x361f0000,0x3aa70000
.long 0x39a80000,0x3bd90000,0x361f0000,0xb8720000,0x39a80000,0xb8720000,0xbb640000,0x323e0000
.long 0xb9a80000,0xb8720000,0x3b640000,0x323e0000,0xb9a80000,0x3bd90000,0xb61f0000,0xb8720000
.long 0x39a80000,0xb23e0000,0xb61f0000,0x3aa70000,0x39a80000,0xbaa70000,0x3b640000,0xbbd90000
.long 0x0,0x361f,0x39a8,0x3b64,0x0,0xb9a8,0xbc00,0xb9a8
.long 0x0,0x3b64,0x39a8,0xb61f,0x0,0xbc00,0x0,0x3c00
.long 0x0,0x3b64,0xb9a8,0xb61f,0x0,0xb9a8,0x3c00,0xb9a8
.long 0x0,0x361f,0xb9a8,0x3b64,0x0,0x0,0x0,0x0
.long 0xbc000000,0xbbd90000,0xbb640000,0xbaa70000,0x3c000000,0x3aa70000,0x361f0000,0xb23e0000
.long 0xbc000000,0xb8720000,0x361f0000,0x3bd90000,0x3c000000,0x323e0000,0xbb640000,0xb8720000
.long 0xbc000000,0x323e0000,0x3b640000,0xb8720000,0x3c000000,0xb8720000,0xb61f0000,0x3bd90000
.long 0xbc000000,0x3aa70000,0xb61f0000,0xb23e0000,0x3c000000,0xbbd90000,0x3b640000,0xbaa70000
.long 0x3c00,0x3b64,0x39a8,0x361f,0x0,0x39a8,0x3c00,0x39a8
.long 0xbc00,0xb61f,0x39a8,0x3b64,0x0,0xbc00,0x0,0x3c00
.long 0x3c00,0xb61f,0xb9a8,0x3b64,0x0,0x39a8,0xbc00,0x39a8
.long 0xbc00,0x3b64,0xb9a8,0x361f,0x0,0x0,0x0,0x0
.long 0xb9a80000,0xb8720000,0xb61f0000,0xb23e0000,0xb9a80000,0xbbd90000,0xbb640000,0xb8720000
.long 0x39a80000,0xb23e0000,0xbb640000,0xbaa70000,0x39a80000,0x3aa70000,0xb61f0000,0xbbd90000
.long 0xb9a80000,0x3aa70000,0x361f0000,0xbbd90000,0xb9a80000,0xb23e0000,0x3b640000,0xbaa70000
.long 0x39a80000,0xbbd90000,0x3b640000,0xb8720000,0x39a80000,0xb8720000,0x361f0000,0xb23e0000
.size L_TBL, 8192
.section .rodata,"a"
.p2align 6
.amdhsa_kernel sequential_preLN__spectral_fnet__geglu_ffn__prompt_kernel
  .amdhsa_next_free_vgpr 512
  .amdhsa_next_free_sgpr 102
  .amdhsa_accum_offset 256
  .amdhsa_group_segment_fixed_size 0
  .amdhsa_kernarg_size 96
  .amdhsa_user_sgpr_count 2
  .amdhsa_user_sgpr_kernarg_segment_ptr 1
  .amdhsa_system_sgpr_workgroup_id_x 1
  .amdhsa_float_denorm_mode_32 3
.end_amdhsa_kernel
```
